```python
import torch

def _softmax(x, axis=-1):
    return torch.softmax(x, dim=axis)
def _gelu(x):
    return torch.nn.functional.gelu(x, approximate="tanh")
def _silu(x):
    return torch.nn.functional.silu(x)
def _sigmoid(x):
    return torch.sigmoid(x)
def _layernorm(x, axis=-1, eps=1e-5):
    m = x.mean(dim=axis, keepdim=True)
    v = x.var(dim=axis, keepdim=True, unbiased=False)
    return (x - m) / torch.sqrt(v + eps)
def _scatter_add(tgt, idx, src, axis=0):
    return tgt.clone().index_add_(axis, idx, src)
def _segment_sum(src, seg, n):
    out = torch.zeros((n,) + src.shape[1:], dtype=src.dtype)
    return out.index_add_(0, seg, src)
def _pad(x, pw):
    flat = tuple(v for pair in reversed(pw) for v in pair)
    return torch.nn.functional.pad(x, flat)

kernel_name = 'parallel_sum__grouped_kv_mqa__dense_activation_silu__prompt'

def setup_inputs():

    _w = (lambda a: (lambda t: t.to(torch.bfloat16) if t.is_floating_point() else t)(torch.as_tensor(a)))
    def _A_setup():
        B, S, D, H = 1, 2048, 640, 32
        Dh = D // H
        return {
            "x": _w((lambda *s: torch.randn(*s, dtype=torch.bfloat16) * 0.05)(B, S, D)),
            "wq": _w((lambda *s: torch.randn(*s, dtype=torch.bfloat16) * 0.05)(D, H * Dh)),
            "wk": _w((lambda *s: torch.randn(*s, dtype=torch.bfloat16) * 0.05)(D, Dh)),
            "wv": _w((lambda *s: torch.randn(*s, dtype=torch.bfloat16) * 0.05)(D, Dh)),
            "wo": _w((lambda *s: torch.randn(*s, dtype=torch.bfloat16) * 0.05)(H * Dh, D)),
        }
    _A_in = _A_setup()

    def _B_setup():
        B, S, D, F = 1, 2048, 640, 1536
        return {
            "x": _w((lambda *s: torch.randn(*s, dtype=torch.bfloat16) * 0.05)(B, S, D)),
            "w1": _w((lambda *s: torch.randn(*s, dtype=torch.bfloat16) * 0.8)(D, F) * (D ** -0.5)),
            "w2": _w((lambda *s: torch.randn(*s, dtype=torch.bfloat16) * 0.8)(F, D) * (F ** -0.5)),
        }
    _B_in = _B_setup()

    return {
        "A_x": _A_in["x"],
        "A_wq": _A_in["wq"],
        "A_wk": _A_in["wk"],
        "A_wv": _A_in["wv"],
        "A_wo": _A_in["wo"],
        "B_x": _B_in["x"],
        "B_w1": _B_in["w1"],
        "B_w2": _B_in["w2"],
    }

def reference(A_x, A_wq, A_wk, A_wv, A_wo, B_x, B_w1, B_w2):
    def _A_ref(x, wq, wk, wv, wo):
        B, S, D = x.shape
        H = 32
        Dh = D // H
        q = (lambda x, *d: x.permute(*d))((x @ wq).reshape(B, S, H, Dh), 0, 2, 1, 3)
        k = x @ wk
        v = x @ wv
        scores = torch.einsum("bhqd,bkd->bhqk", q, k) * (Dh ** -0.5)
        p = _softmax(scores, axis=-1)
        o = torch.einsum("bhqk,bkd->bhqd", p, v)
        return (lambda x, *d: x.permute(*d))(o, 0, 2, 1, 3).reshape(B, S, H * Dh) @ wo

    def _B_ref(x, w1, w2):
        h = torch.einsum("bsd,df->bsf", x, w1)
        h = _silu(h)
        out = torch.einsum("bsf,fd->bsd", h, w2)
        return out

    x = A_x
    xn = _layernorm(x, axis=-1)
    return x + _A_ref(xn, A_wq, A_wk, A_wv, A_wo) + _B_ref(xn, B_w1, B_w2)
```

```asm
; @launch grid=(256,1,1) block=(768,1,1) lds=163840
.amdgcn_target "amdgcn-amd-amdhsa--gfx950"
.text
.globl parallel_sum__grouped_kv_mqa__dense_activation_silu__prompt_kernel
.p2align 8
.type parallel_sum__grouped_kv_mqa__dense_activation_silu__prompt_kernel,@function
parallel_sum__grouped_kv_mqa__dense_activation_silu__prompt_kernel:
    s_cmp_ge_u32 s2, 256
    s_cbranch_scc1 K_end
    s_load_dwordx8 s[8:15], s[0:1], 0
    s_load_dwordx4 s[60:63], s[0:1], 48
    s_load_dwordx4 s[4:7], s[0:1], 72
    s_load_dwordx2 s[16:17], s[0:1], 32
    s_load_dwordx2 s[18:19], s[0:1], 64
    v_lshrrev_b32 v1, 6, v0
    v_and_b32 v0, 63, v0
    v_readfirstlane_b32 s32, v1
    s_lshr_b32 s42, s2, 3
    s_and_b32 s41, s2, 3
    s_bfe_u32 s49, s2, 0x10002
    s_mul_i32 s49, s49, 3
    v_lshrrev_b32 v24, 5, v0
    v_and_b32 v25, 3, v0
    v_bfe_u32 v26, v0, 2, 3
    v_lshlrev_b32 v27, 4, v25
    s_mov_b32 s30, 22020096
    s_mov_b32 s31, 0x00020000
    s_cmp_lt_u32 s42, 12
    s_cbranch_scc0 K1_mh
    s_mul_i32 s35, s42, 86
    s_lshr_b32 s35, s35, 8
    s_mul_i32 s48, s35, 3
    s_sub_u32 s36, s42, s48
    s_add_u32 s36, s36, s49
    s_cmp_eq_u32 s36, 5
    s_cselect_b32 s36, 17, s36
    s_lshl_b32 s41, s41, 2
    s_add_u32 s35, s35, s41
    s_mov_b32 s44, 2
    s_branch K1_md
K1_mh:
    s_mul_i32 s48, s41, 20
    s_add_u32 s48, s48, s42
    s_sub_u32 s48, s48, 12
    s_cmp_ge_u32 s48, 78
    s_cbranch_scc1 K1_aux
    s_mul_i32 s35, s48, 43
    s_lshr_b32 s35, s35, 8
    s_mul_i32 s41, s35, 6
    s_sub_u32 s36, s48, s41
    s_lshl_b32 s49, s49, 1
    s_add_u32 s36, s36, s49
    s_add_u32 s36, s36, 5
    s_mov_b32 s44, 3
K1_md:
    s_and_b32 s33, s32, 3
    s_add_u32 s41, s44, 2
    s_mul_i32 s50, s35, s41
    s_add_u32 s39, s35, s36
    s_mul_i32 s39, s39, 3
    s_mul_i32 s41, s39, 6554
    s_lshr_b32 s41, s41, 16
    s_mul_i32 s41, s41, 10
    s_sub_u32 s39, s39, s41
    s_cmp_lt_u32 s32, 8
    s_cbranch_scc1 K1_C
    s_lshl_b32 s41, s50, 5
    s_lshl_b32 s42, s33, 3
    s_add_u32 s41, s41, s42
    s_mul_i32 s41, s41, 1280
    v_lshrrev_b32 v28, 3, v0
    v_mul_u32_u24 v28, 1280, v28
    v_add_u32 v28, s41, v28
    v_and_b32 v29, 7, v0
    v_lshrrev_b32 v30, 4, v0
    v_xor_b32 v29, v29, v30
    s_and_b32 s41, s33, 1
    s_lshl_b32 s41, s41, 2
    v_xor_b32 v29, s41, v29
    v_lshl_add_u32 v1, v29, 4, v28
    s_cmp_lt_u32 s36, 5
    s_movk_i32 s41, 3072
    s_cselect_b32 s41, 1280, s41
    s_cselect_b32 s48, 0, 5
    s_sub_u32 s48, s36, s48
    s_lshl_b32 s48, s48, 8
    v_lshl_add_u32 v28, v24, 6, v27
    v_add_u32 v28, s48, v28
    v_add_u32 v29, s42, v26
    v_mad_u32_u24 v2, v29, s41, v28
    v_min_u32 v28, 24, v27
    v_mad_u32_u24 v30, v29, 40, v28
    v_mov_b32 v31, 0
    v_cmp_eq_u32 vcc, 0, v24
    v_mov_b32 v8, 2560
    s_lshl_b32 s45, s41, 6
    s_lshl_b32 s55, s41, 5
    s_mul_i32 s26, s41, 640
    s_lshl_b32 s40, s33, 10
    s_add_u32 s43, s40, 122880
    s_mov_b32 s38, 0
    s_mov_b32 s22, 2621440
    s_mov_b32 s23, 0x00020000
    s_mov_b32 s27, 0x00020000
    s_cmp_lt_u32 s36, 5
    s_waitcnt lgkmcnt(0)
    s_mov_b32 s20, s8
    s_mov_b32 s21, s9
    s_cselect_b32 s24, s10, s60
    s_cselect_b32 s25, s11, s61
K1_issue:
    s_lshl_b32 s41, s39, 7
    s_mov_b32 m0, s40
    s_mul_i32 s42, s39, s45
    buffer_load_dwordx4 v1, s[20:23], s41 offen lds
    s_add_u32 m0, m0, 4096
    s_add_u32 s41, s41, 40960
    buffer_load_dwordx4 v1, s[20:23], s41 offen lds
    s_add_u32 m0, m0, 4096
    s_add_u32 s41, s41, 40960
    buffer_load_dwordx4 v1, s[20:23], s41 offen lds
    s_add_u32 m0, m0, 4096
    s_add_u32 s41, s41, 40960
    buffer_load_dwordx4 v1, s[20:23], s41 offen lds
    s_add_u32 m0, m0, 4096
    s_add_u32 s41, s41, 40960
    s_cmp_eq_u32 s44, 2
    s_cbranch_scc1 K1_i1
    buffer_load_dwordx4 v1, s[20:23], s41 offen lds
    s_add_u32 m0, m0, 4096
    s_add_u32 s41, s41, 40960
K1_i1:
    s_add_u32 m0, s40, 24576
    s_add_u32 s48, s42, s55
    s_cmp_eq_u32 s36, 17
    s_cbranch_scc1 K1_ikv
    buffer_load_dwordx4 v2, s[24:27], s42 offen lds
    s_add_u32 m0, m0, 4096
    s_nop 0
    buffer_load_dwordx4 v2, s[24:27], s48 offen lds
    s_add_u32 m0, m0, 3968
    s_nop 0
    buffer_load_dwordx4 v2, s[24:27], s42 offen offset:128 lds
    s_add_u32 m0, m0, 4096
    s_cmp_eq_u32 s44, 3
    buffer_load_dwordx4 v2, s[24:27], s48 offen offset:128 lds
    s_cbranch_scc1 K1_i2
    s_waitcnt vmcnt(8)
K1_i2:
    s_add_u32 s39, s39, 1
    s_cmp_eq_u32 s39, 10
    s_cselect_b32 s39, 0, s39
    s_add_u32 s40, s40, 40960
    s_cmp_eq_u32 s40, s43
    s_cselect_b32 s41, 122880, 0
    s_sub_u32 s40, s40, s41
    s_add_u32 s38, s38, 1
    s_cmp_eq_u32 s38, 1
    s_cbranch_scc1 K1_issue
    s_waitcnt vmcnt(9)
    s_barrier
    s_cmp_lg_u32 s38, 10
    s_cbranch_scc1 K1_issue
    s_branch K1_g0
K1_ikv:
    v_mov_b32 v4, s14
    v_mov_b32 v5, s15
    v_mov_b32 v6, s12
    v_mov_b32 v7, s13
    v_cndmask_b32 v4, v4, v6, vcc
    v_cndmask_b32 v5, v5, v7, vcc
    v_lshl_add_u64 v[4:5], v[30:31], 0, v[4:5]
    v_mad_u64_u32 v[6:7], s[58:59], v8, s39, v[4:5]
    global_load_lds_dwordx4 v[6:7], off
    s_add_u32 m0, m0, 2816
    s_nop 0
    global_load_lds_dwordx4 v[6:7], off offset:1280
    s_waitcnt vmcnt(6)
    s_branch K1_i2
K1_g0:
    s_setprio 3
    s_mov_b32 s28, s6
    s_mov_b32 s29, s7
    v_mov_b32 v22, 142848
    ds_read_b32 v21, v22
    s_lshl_b32 s48, s33, 6
    v_add_u32 v20, s48, v0
    s_lshl_b32 s41, s50, 5
    v_add_u32 v23, s41, v20
    v_min_u32 v23, 2047, v23
    s_mul_i32 s52, s36, 10240
    s_add_u32 s52, s52, 2957312
    s_cmp_eq_u32 s33, 3
    s_mov_b32 s57, 32768
    s_cselect_b32 s57, 1024, s57
    s_cselect_b32 s52, s52, 2621440
    s_cselect_b64 vcc, -1, 0
    s_mov_b32 s38, 0
    v_cndmask_b32 v23, v23, v0, vcc
    v_lshlrev_b32 v23, 4, v23
    s_cmp_eq_u32 s33, s44
    s_cselect_b32 s41, s33, 0
    s_cmp_eq_u32 s41, 2
    s_cbranch_scc1 K1_g6
K1_gat:
    s_mov_b32 s41, s52
    buffer_load_dwordx4 v[32:35], v23, s[28:31], s41 offen sc1
    s_add_u32 s41, s41, s57
    buffer_load_dwordx4 v[36:39], v23, s[28:31], s41 offen sc1
    s_add_u32 s41, s41, s57
    buffer_load_dwordx4 v[40:43], v23, s[28:31], s41 offen sc1
    s_add_u32 s41, s41, s57
    buffer_load_dwordx4 v[44:47], v23, s[28:31], s41 offen sc1
    s_add_u32 s41, s41, s57
    buffer_load_dwordx4 v[48:51], v23, s[28:31], s41 offen sc1
    s_add_u32 s41, s41, s57
    buffer_load_dwordx4 v[52:55], v23, s[28:31], s41 offen sc1
    s_add_u32 s41, s41, s57
    buffer_load_dwordx4 v[56:59], v23, s[28:31], s41 offen sc1
    s_add_u32 s41, s41, s57
    buffer_load_dwordx4 v[60:63], v23, s[28:31], s41 offen sc1
    s_add_u32 s41, s41, s57
    buffer_load_dwordx4 v[64:67], v23, s[28:31], s41 offen sc1
    s_add_u32 s41, s41, s57
    buffer_load_dwordx4 v[68:71], v23, s[28:31], s41 offen sc1
    s_add_u32 s41, s41, s57
    s_cmp_lg_u32 s38, 0
    s_cbranch_scc1 K1_g2
    s_waitcnt vmcnt(10)
    s_barrier
    s_mul_i32 s58, s50, 98304
    s_lshl_b32 s41, s36, 2
    s_add_u32 s41, s41, s33
    s_lshl_b32 s42, s41, 11
    s_add_u32 s58, s58, s42
    s_add_u32 s58, s58, 3366912
    s_lshl_b32 s59, s41, 5
    s_add_u32 s59, s59, s35
    s_lshl_b32 s59, s59, 7
    s_add_u32 s59, s59, 16777216
    s_cmp_eq_u32 s44, 3
    s_cselect_b32 s58, s58, 0
K1_pk:
    s_lshr_b32 s41, s2, 3
    s_and_b32 s42, s2, 3
    s_mul_i32 s48, s42, 12
    s_add_u32 s48, s48, s41
    s_mul_i32 s49, s41, 86
    s_lshr_b32 s49, s49, 8
    s_sub_u32 s49, s41, s49
    s_lshl_b32 s42, s42, 3
    s_add_u32 s49, s49, s42
    s_add_u32 s49, s49, 48
    s_bitcmp1_b32 s2, 2
    s_cselect_b32 s48, s49, s48
    s_sub_u32 s49, s2, 16
    s_cmp_lt_u32 s2, 96
    s_cselect_b32 s65, s48, s49
    s_lshl_b32 s65, s65, 2
    s_add_u32 s65, s65, s33
    s_mov_b32 s39, s65
    s_cmp_lg_u32 s36, 17
    s_cbranch_scc1 K1_pk2
    s_mov_b32 s65, 0x4000
    s_cmp_eq_u32 s44, 1
    s_cbranch_scc1 K1_gd
    s_branch K1_g2
K1_pk2:
    s_lshl_b32 s41, s33, 10
    s_add_u32 m0, s41, 122880
    s_mov_b32 s27, 0x00020000
    v_lshl_add_u32 v27, v24, 6, v27
    v_lshrrev_b32 v30, 2, v26
    v_and_b32 v31, 3, v26
K1_a1:
    s_mul_i32 s41, s39, 6554
    s_lshr_b32 s41, s41, 16
    s_mul_i32 s42, s41, 10
    s_sub_u32 s42, s39, s42
    s_lshl_b32 s42, s42, 7
    s_sub_u32 s48, s41, 96
    s_mul_i32 s49, s48, 205
    s_lshr_b32 s49, s49, 10
    s_mul_i32 s55, s49, 5
    s_sub_u32 s55, s48, s55
    s_mul_i32 s49, s49, 80
    s_mul_i32 s56, s55, 20
    s_cmp_eq_u32 s55, 4
    s_cselect_b32 s56, 16, s56
    s_cselect_b32 s55, 1, 0
    s_add_u32 s49, s49, s56
    s_lshl_b32 s48, s41, 4
    s_cmp_lt_u32 s41, 96
    s_cselect_b32 s49, s48, s49
    s_cselect_b32 s55, 0, s55
    s_cselect_b32 s24, s62, s16
    s_cselect_b32 s25, s63, s17
    s_mov_b32 s26, 819200
    s_cselect_b32 s26, 1966080, s26
    s_mul_i32 s49, s49, 1280
    s_add_u32 s56, s49, s42
    s_cmp_eq_u32 s55, 0
    s_cselect_b32 s48, 4, 40
    s_movk_i32 s55, 25600
    s_cselect_b32 s55, 10240, s55
    s_add_u32 s55, s55, s56
    v_mad_u32_u24 v2, v30, s48, v31
    v_mul_u32_u24 v2, 1280, v2
    v_add_u32 v2, v2, v27
    buffer_load_dwordx4 v2, s[24:27], s56 offen lds
    s_add_u32 m0, m0, 4096
    s_add_u32 s39, s39, 960
    buffer_load_dwordx4 v2, s[24:27], s55 offen lds
    s_add_u32 m0, m0, 4096
    s_cmp_lt_u32 s39, 1360
    s_cbranch_scc1 K1_a1
    s_cmp_eq_u32 s44, 0
    s_cbranch_scc1 K2_G
    s_cmp_eq_u32 s44, 1
    s_cbranch_scc1 K1_gd
    s_cmp_lt_u32 s39, 1920
    s_cbranch_scc1 K1_g4
    s_waitcnt vmcnt(4)
    s_branch K1_g5
K1_g6:
    s_mov_b32 s58, 0
    s_mov_b32 s44, 1
    s_waitcnt vmcnt(0) lgkmcnt(0)
    s_barrier
    v_readfirstlane_b32 s68, v21
    s_branch K1_pk
K1_g2:
    s_waitcnt vmcnt(0)
K1_g4:
    s_waitcnt vmcnt(2)
K1_g5:
    s_add_u32 s38, s38, 1
    s_waitcnt lgkmcnt(0)
    v_cmp_eq_u32 vcc, 0, v21
    v_readfirstlane_b32 s68, v21
    s_nop 0
    v_cndmask_b32 v6, 0, 1, vcc
    v_xor_b32 v33, v33, v21
    v_xor_b32 v35, v35, v21
    v_or3_b32 v6, v33, v35, v6
    v_xor_b32 v37, v37, v21
    v_xor_b32 v39, v39, v21
    v_or3_b32 v6, v37, v39, v6
    v_xor_b32 v41, v41, v21
    v_xor_b32 v43, v43, v21
    v_or3_b32 v6, v41, v43, v6
    v_xor_b32 v45, v45, v21
    v_xor_b32 v47, v47, v21
    v_or3_b32 v6, v45, v47, v6
    v_xor_b32 v49, v49, v21
    v_xor_b32 v51, v51, v21
    v_or3_b32 v6, v49, v51, v6
    v_xor_b32 v53, v53, v21
    v_xor_b32 v55, v55, v21
    v_or3_b32 v6, v53, v55, v6
    v_xor_b32 v57, v57, v21
    v_xor_b32 v59, v59, v21
    v_or3_b32 v6, v57, v59, v6
    v_xor_b32 v61, v61, v21
    v_xor_b32 v63, v63, v21
    v_or3_b32 v6, v61, v63, v6
    v_xor_b32 v65, v65, v21
    v_xor_b32 v67, v67, v21
    v_or3_b32 v6, v65, v67, v6
    v_xor_b32 v69, v69, v21
    v_xor_b32 v71, v71, v21
    v_or3_b32 v6, v69, v71, v6
    v_cmp_ne_u32 vcc, 0, v6
    s_cbranch_vccz K1_g3
    s_sleep 4
    s_cmp_lt_u32 s38, 200000
    s_cbranch_scc1 K1_gat
K1_g3:
    v_add_f32 v32, v32, v36
    v_add_f32 v34, v34, v38
    v_add_f32 v32, v32, v40
    v_add_f32 v34, v34, v42
    v_add_f32 v32, v32, v44
    v_add_f32 v34, v34, v46
    v_add_f32 v32, v32, v48
    v_add_f32 v34, v34, v50
    v_add_f32 v32, v32, v52
    v_add_f32 v34, v34, v54
    v_add_f32 v32, v32, v56
    v_add_f32 v34, v34, v58
    v_add_f32 v32, v32, v60
    v_add_f32 v34, v34, v62
    v_add_f32 v32, v32, v64
    v_add_f32 v34, v34, v66
    v_add_f32 v32, v32, v68
    v_add_f32 v34, v34, v70
    s_cmp_eq_u32 s33, 3
    s_cbranch_scc1 K1_gc
    v_mul_f32 v32, 0x3acccccd, v32
    v_mul_f32 v34, 0x3acccccd, v34
    v_cvt_pk_bf16_f32 v36, -v32, -v32
    v_fma_f32 v34, -v32, v32, v34
    v_max_f32 v34, 0, v34
    v_cvt_pk_bf16_f32 v34, v34, v34
    v_lshlrev_b32 v34, 16, v34
    v_add_f32 v34, 0x3727c5ac, v34
    v_cvt_pk_bf16_f32 v34, v34, v34
    v_lshlrev_b32 v34, 16, v34
    v_sqrt_f32 v38, v34
    v_mov_b32 v37, 0
    v_cvt_pk_bf16_f32 v38, v38, v38
    v_lshlrev_b32 v38, 16, v38
    v_rcp_f32 v39, v38
    s_cmp_eq_u32 s36, 17
    s_mov_b32 s41, 0x3ea52b5c
    s_cselect_b32 s41, 1.0, s41
    s_cmp_eq_u32 s44, 3
    s_cselect_b32 s41, 0xbfb8aa3b, s41
    v_lshlrev_b32 v5, 4, v20
    v_add_u32 v5, 139264, v5
    v_mul_f32 v39, s41, v39
    ds_write_b128 v5, v[36:39]
    s_branch K1_gd
K1_gc:
    v_and_b32 v33, 0xffff0000, v32
    v_and_b32 v35, 0xffff0000, v34
    v_sub_f32 v32, v32, v33
    v_sub_f32 v34, v34, v35
    v_cvt_pk_bf16_f32 v36, v33, v32
    v_cvt_pk_bf16_f32 v37, v35, v34
    v_lshlrev_b32 v5, 3, v0
    v_add_u32 v5, 142336, v5
    ds_write_b64 v5, v[36:37]
K1_gd:
    s_waitcnt lgkmcnt(0)
    s_barrier
    s_branch K2_G
K1_C:
    s_memrealtime s[66:67]
    v_bfe_u32 v28, v0, 2, 2
    v_bfe_u32 v29, v0, 4, 1
    v_lshl_add_u32 v28, v28, 1, v29
    v_lshl_add_u32 v28, v28, 2, v25
    v_lshlrev_b32 v11, 3, v28
    s_mov_b32 s22, 256
    s_mov_b32 s23, 0x00020000
    v_mov_b32 v3, 0
    s_waitcnt lgkmcnt(0)
    s_mov_b32 s28, s6
    s_mov_b32 s29, s7
    s_mov_b32 s20, s4
    s_mov_b32 s21, s5
    s_or_b32 s41, s2, s32
    s_cbranch_scc1 K1_nn
    s_or_b32 s41, s66, 1
    v_mov_b32 v2, s41
    s_mov_b64 exec, 1
    buffer_atomic_cmpswap v[2:3], v3, s[20:23], 0 offen
    s_mov_b64 exec, -1
K1_nn:
    s_lshr_b32 s34, s32, 2
    s_mov_b32 s37, 0x3f803f80
    s_sub_u32 s41, s32, 2
    s_cmp_lt_u32 s41, 4
    s_cselect_b32 s69, 1, 0
    s_cmp_eq_u32 s36, 17
    s_cselect_b32 s69, s69, 0
    s_cselect_b32 s41, 1, 3
    s_and_b32 s41, s41, s33
    s_lshr_b32 s42, s41, 1
    s_lshl_b32 s42, s42, 13
    s_and_b32 s41, s41, 1
    s_lshl_b32 s41, s41, 9
    s_add_u32 s41, s41, s42
    s_add_u32 s41, s41, 24576
    v_lshl_add_u32 v16, v24, 10, v11
    v_add_u32 v16, s41, v16
    v_and_b32 v10, 31, v0
    v_bfe_u32 v29, v0, 1, 3
    v_lshlrev_b32 v28, 7, v10
    s_lshl_b32 s42, s32, 12
    v_lshlrev_b32 v30, 2, v24
    v_xor_b32 v30, v30, v29
    v_lshl_add_u32 v4, v30, 4, v28
    v_add_u32 v4, s42, v4
    v_xor_b32 v5, 16, v4
    v_xor_b32 v6, 32, v4
    v_xor_b32 v7, 48, v4
    v_xor_b32 v29, v29, v24
    s_mul_i32 s41, s34, s44
    s_add_u32 s54, s50, s41
    s_lshl_b32 s42, s41, 12
    v_add_u32 v28, s42, v28
    s_lshl_b32 s42, s41, 9
    s_add_u32 s42, s42, 139264
    v_lshl_add_u32 v17, v10, 4, s42
    s_lshl_b32 s42, s33, 7
    s_add_u32 s42, s42, 142336
    v_lshl_add_u32 v18, v10, 2, s42
    v_lshlrev_b32 v1, 4, v0
    v_mov_b32 v9, 142848
    v_xor_b32 v30, 0, v29
    v_lshl_add_u32 v12, v30, 4, v28
    v_xor_b32 v30, 2, v29
    v_lshl_add_u32 v13, v30, 4, v28
    v_xor_b32 v30, 4, v29
    v_lshl_add_u32 v14, v30, 4, v28
    v_xor_b32 v30, 6, v29
    v_lshl_add_u32 v15, v30, 4, v28
    v_mov_b64 v[32:33], 0
    v_mov_b64 v[34:35], 0
    v_mov_b64 v[36:37], 0
    v_mov_b64 v[38:39], 0
    v_mov_b64 v[40:41], 0
    v_mov_b64 v[42:43], 0
    v_mov_b64 v[44:45], 0
    v_mov_b64 v[46:47], 0
    v_mov_b64 v[48:49], 0
    v_mov_b64 v[50:51], 0
    v_mov_b64 v[52:53], 0
    v_mov_b64 v[54:55], 0
    v_mov_b64 v[56:57], 0
    v_mov_b64 v[58:59], 0
    v_mov_b64 v[60:61], 0
    v_mov_b64 v[62:63], 0
    v_mov_b64 v[64:65], 0
    v_mov_b64 v[66:67], 0
    v_mov_b64 v[68:69], 0
    v_mov_b64 v[70:71], 0
    v_mov_b64 v[72:73], 0
    v_mov_b64 v[74:75], 0
    v_mov_b64 v[76:77], 0
    v_mov_b64 v[78:79], 0
    s_and_b32 s96, s2, 3
    s_lshl_b32 s100, s96, 2
    s_bfe_u32 s96, s2, 0x20003
    s_add_u32 s100, s100, s96
    s_lshl_b32 s100, s100, 2
    s_and_b32 s98, s32, 3
    s_add_u32 s100, s100, s98
    s_bfe_u32 s96, s2, 0x10002
    s_lshl_b32 s99, s96, 1
    s_lshr_b32 s96, s2, 7
    s_add_u32 s99, s99, s96
    s_lshl_b32 s99, s99, 3
    s_bfe_u32 s97, s2, 0x20005
    s_add_u32 s99, s99, s97
    s_and_b32 s96, s32, 4
    s_add_u32 s99, s99, s96
    s_lshl_b32 s98, s98, 12
    s_lshl_b32 s96, s96, 9
    s_add_u32 s98, s98, s96
    s_add_u32 s98, s98, 147456
    v_lshlrev_b32 v2, 4, v0
    v_and_b32 v164, 31, v0
    v_lshlrev_b32 v164, 4, v164
    v_lshrrev_b32 v19, 5, v0
    v_add_u32 v165, s97, v19
    v_add_u32 v166, 2, v165
    s_add_u32 s96, s97, 4
    v_mov_b32 v167, s96
    v_lshrrev_b32 v22, 2, v165
    v_lshl_add_u32 v23, v22, 10, v164
    v_and_b32 v22, 1, v165
    v_lshl_add_u32 v23, v22, 9, v23
    v_and_b32 v22, 2, v165
    v_lshl_add_u32 v23, v22, 2, v23
    v_add_u32 v165, s98, v23
    v_lshrrev_b32 v22, 2, v166
    v_lshl_add_u32 v23, v22, 10, v164
    v_and_b32 v22, 1, v166
    v_lshl_add_u32 v23, v22, 9, v23
    v_and_b32 v22, 2, v166
    v_lshl_add_u32 v23, v22, 2, v23
    v_add_u32 v166, s98, v23
    v_lshrrev_b32 v22, 2, v167
    v_lshl_add_u32 v23, v22, 10, v164
    v_and_b32 v22, 1, v167
    v_lshl_add_u32 v23, v22, 9, v23
    v_and_b32 v22, 2, v167
    v_lshl_add_u32 v23, v22, 2, v23
    v_add_u32 v167, s98, v23
    v_mul_u32_u24 v19, 5120, v19
    v_add_u32 v164, v164, v19
    v_and_b32 v19, 27, v0
    v_cmp_eq_u32 vcc, 24, v19
    v_mov_b32 v19, 0x3f803f80
    s_mov_b32 s94, 0x000fffff
    s_mov_b32 s95, 0x000fffff
    v_cndmask_b32 v22, 0, v19, vcc
    v_cndmask_b32 v23, 0, v19, vcc
    s_lshr_b32 s90, s99, 2
    s_mul_i32 s90, s90, 5
    s_mul_i32 s91, s100, 40
    s_add_u32 s90, s90, s91
    s_lshl_b32 s90, s90, 10
    s_add_u32 s90, s90, 9699328
    s_lshl_b32 s91, s97, 10
    s_add_u32 s91, s91, s90
    s_lshr_b32 s98, s97, 1
    s_lshl_b32 s98, s98, 9
    s_add_u32 s90, s90, s98
    s_and_b32 s98, s97, 1
    s_lshl_b32 s98, s98, 3
    s_add_u32 s90, s90, s98
    s_add_u32 s90, s90, 4096
    s_lshl_b32 s92, s100, 5
    s_add_u32 s92, s92, s99
    s_lshl_b32 s92, s92, 7
    s_add_u32 s92, s92, 17301504
    s_mov_b32 s38, 9
    s_mov_b32 s47, 0
    s_mov_b32 s46, 40960
    s_cmp_lg_u32 s69, 0
    s_cbranch_scc1 K1_idle
    s_add_u32 s41, s50, s32
    s_lshl_b32 s48, s39, 6
    s_add_u32 s48, s48, s41
    s_lshl_b32 s48, s48, 9
    s_add_u32 s48, s48, 2621440
    s_cmp_lt_u32 s41, 64
    s_cselect_b32 s48, s48, 22020096
    s_sub_u32 s41, s36, 5
    s_cmp_lt_u32 s41, 10
    s_cselect_b32 s41, 5, 0
    s_cmp_lt_u32 s32, s41
    s_cselect_b32 s48, s48, 22020096
    s_mul_i32 s52, s36, 10
    s_add_u32 s52, s52, s39
    s_lshl_b32 s52, s52, 10
    s_add_u32 s52, s52, 2957312
    s_lshl_b32 s42, s33, 8
    s_add_u32 s52, s52, s42
    s_cmp_lt_u32 s35, 10
    s_cselect_b32 s41, s34, 0
    s_cmp_lg_u32 s41, 0
    s_cselect_b32 s52, s52, 22020096
    s_xor_b32 s49, s52, 512
    v_mov_b32 v160, 0
    v_mov_b32 v162, 0
    v_mov_b32 v20, 0
    v_lshlrev_b32 v8, 3, v0
    s_barrier
    buffer_load_dword v161, v3, s[20:23], 0 offen sc1
    s_cmp_eq_u32 s48, 22020096
    s_cbranch_scc1 K1_nr
    ds_read_b128 v[144:147], v4
    ds_read_b128 v[148:151], v5
    ds_read_b128 v[152:155], v6
    ds_read_b128 v[156:159], v7
    s_waitcnt lgkmcnt(0)
    v_dot2c_f32_bf16 v160, s37, v144
    v_dot2c_f32_bf16 v162, v144, v144
    v_dot2c_f32_bf16 v160, s37, v145
    v_dot2c_f32_bf16 v162, v145, v145
    v_dot2c_f32_bf16 v160, s37, v146
    v_dot2c_f32_bf16 v162, v146, v146
    v_dot2c_f32_bf16 v160, s37, v147
    v_dot2c_f32_bf16 v162, v147, v147
    v_dot2c_f32_bf16 v160, s37, v148
    v_dot2c_f32_bf16 v162, v148, v148
    v_dot2c_f32_bf16 v160, s37, v149
    v_dot2c_f32_bf16 v162, v149, v149
    v_dot2c_f32_bf16 v160, s37, v150
    v_dot2c_f32_bf16 v162, v150, v150
    v_dot2c_f32_bf16 v160, s37, v151
    v_dot2c_f32_bf16 v162, v151, v151
    v_dot2c_f32_bf16 v160, s37, v152
    v_dot2c_f32_bf16 v162, v152, v152
    v_dot2c_f32_bf16 v160, s37, v153
    v_dot2c_f32_bf16 v162, v153, v153
    v_dot2c_f32_bf16 v160, s37, v154
    v_dot2c_f32_bf16 v162, v154, v154
    v_dot2c_f32_bf16 v160, s37, v155
    v_dot2c_f32_bf16 v162, v155, v155
    v_dot2c_f32_bf16 v160, s37, v156
    v_dot2c_f32_bf16 v162, v156, v156
    v_dot2c_f32_bf16 v160, s37, v157
    v_dot2c_f32_bf16 v162, v157, v157
    v_dot2c_f32_bf16 v160, s37, v158
    v_dot2c_f32_bf16 v162, v158, v158
    v_dot2c_f32_bf16 v160, s37, v159
    v_dot2c_f32_bf16 v162, v159, v159
    s_nop 2
    v_mov_b32 v5, v160
    v_mov_b32 v6, v162
    s_nop 1
    v_permlane32_swap_b32 v5, v160
    v_permlane32_swap_b32 v6, v162
    v_add_f32 v160, v160, v5
    v_add_f32 v162, v162, v6
K1_nr:
    s_cmp_eq_u32 s52, 22020096
    s_cbranch_scc1 K1_nc
    ds_read_b64_tr_b16 v[144:145], v16 offset:0
    ds_read_b64_tr_b16 v[146:147], v16 offset:256
    ds_read_b64_tr_b16 v[148:149], v16 offset:2048
    ds_read_b64_tr_b16 v[150:151], v16 offset:2304
    ds_read_b64_tr_b16 v[152:153], v16 offset:4096
    ds_read_b64_tr_b16 v[154:155], v16 offset:4352
    ds_read_b64_tr_b16 v[156:157], v16 offset:6144
    ds_read_b64_tr_b16 v[158:159], v16 offset:6400
    s_waitcnt lgkmcnt(0)
    v_dot2c_f32_bf16 v20, s37, v144
    v_dot2c_f32_bf16 v20, s37, v145
    v_dot2c_f32_bf16 v20, s37, v146
    v_dot2c_f32_bf16 v20, s37, v147
    v_dot2c_f32_bf16 v20, s37, v148
    v_dot2c_f32_bf16 v20, s37, v149
    v_dot2c_f32_bf16 v20, s37, v150
    v_dot2c_f32_bf16 v20, s37, v151
    v_dot2c_f32_bf16 v20, s37, v152
    v_dot2c_f32_bf16 v20, s37, v153
    v_dot2c_f32_bf16 v20, s37, v154
    v_dot2c_f32_bf16 v20, s37, v155
    v_dot2c_f32_bf16 v20, s37, v156
    v_dot2c_f32_bf16 v20, s37, v157
    v_dot2c_f32_bf16 v20, s37, v158
    v_dot2c_f32_bf16 v20, s37, v159
    s_nop 2
    v_mov_b32 v5, v20
    s_nop 1
    v_permlane32_swap_b32 v5, v20
    v_add_f32 v20, v20, v5
K1_nc:
    s_sub_u32 s41, s44, s34
    s_cmp_eq_u32 s41, 3
    s_cbranch_scc1 K1_start3
K1_start2:
    ds_read_b64_tr_b16 v[80:81], v16 offset:0
    ds_read_b64_tr_b16 v[82:83], v16 offset:256
    ds_read_b128 v[96:99], v12 offset:0
    ds_read_b128 v[100:103], v12 offset:4096
    ds_read_b64_tr_b16 v[84:85], v16 offset:2048
    ds_read_b64_tr_b16 v[86:87], v16 offset:2304
    ds_read_b128 v[108:111], v13 offset:0
    ds_read_b128 v[112:115], v13 offset:4096
    ds_read_b64_tr_b16 v[88:89], v16 offset:4096
    ds_read_b64_tr_b16 v[90:91], v16 offset:4352
    ds_read_b128 v[120:123], v14 offset:0
    ds_read_b128 v[124:127], v14 offset:4096
    v_add_u32 v12, s46, v12
    v_add_u32 v13, s46, v13
    s_mov_b32 s41, 0
K1_n2:
    s_waitcnt vmcnt(0)
    v_readfirstlane_b32 s68, v161
    s_add_u32 s41, s41, 1
    s_cmp_lg_u32 s68, 0
    s_cbranch_scc1 K1_n2x
    buffer_load_dword v161, v3, s[20:23], 0 offen sc1
    s_cmp_lt_u32 s41, 200000
    s_cbranch_scc1 K1_n2
K1_n2x:
    v_mov_b32 v163, v161
    v_mov_b32 v21, v161
    s_mov_b32 exec_hi, 0
    buffer_store_dwordx4 v[160:163], v1, s[28:31], s48 offen sc1
    buffer_store_dwordx2 v[20:21], v8, s[28:31], s52 offen sc1
    s_cmp_eq_u32 s36, 17
    s_cselect_b32 s49, s49, 22020096
    buffer_store_dwordx2 v[20:21], v8, s[28:31], s49 offen sc1
    s_waitcnt lgkmcnt(0)
    ds_write_b32 v9, v161
    s_mov_b32 exec_hi, -1
    s_branch K1_mid2
K1_comp2:
    v_mfma_f32_32x32x16_bf16 v[32:47], v[88:91], v[120:123], v[32:47]
    ds_read_b64_tr_b16 v[84:85], v16 offset:2048
    ds_read_b64_tr_b16 v[86:87], v16 offset:2304
    v_mfma_f32_32x32x16_bf16 v[48:63], v[88:91], v[124:127], v[48:63]
    ds_read_b128 v[108:111], v13 offset:0
    ds_read_b128 v[112:115], v13 offset:4096
    v_add_u32 v12, s46, v12
    v_mfma_f32_32x32x16_bf16 v[32:47], v[92:95], v[132:135], v[32:47]
    ds_read_b64_tr_b16 v[88:89], v16 offset:4096
    ds_read_b64_tr_b16 v[90:91], v16 offset:4352
    v_mfma_f32_32x32x16_bf16 v[48:63], v[92:95], v[136:139], v[48:63]
    ds_read_b128 v[120:123], v14 offset:0
    ds_read_b128 v[124:127], v14 offset:4096
    v_add_u32 v13, s46, v13
K1_mid2:
    s_waitcnt lgkmcnt(8)
    ds_read_b64_tr_b16 v[92:93], v16 offset:6144
    ds_read_b64_tr_b16 v[94:95], v16 offset:6400
    v_mfma_f32_32x32x16_bf16 v[32:47], v[80:83], v[96:99], v[32:47]
    ds_read_b128 v[132:135], v15 offset:0
    ds_read_b128 v[136:139], v15 offset:4096
    v_add_u32 v14, s46, v14
    v_mfma_f32_32x32x16_bf16 v[48:63], v[80:83], v[100:103], v[48:63]
    v_add_u32 v15, s46, v15
    v_add_u32 v16, s46, v16
    s_cmp_eq_u32 s38, 0
    s_waitcnt lgkmcnt(0)
    s_barrier
    s_cbranch_scc1 K1_tail2
    v_mfma_f32_32x32x16_bf16 v[32:47], v[84:87], v[108:111], v[32:47]
    s_add_u32 s47, s47, 1
    s_cmp_eq_u32 s47, 2
    s_mov_b32 s46, 40960
    s_cselect_b32 s46, 4294885376, s46
    s_cselect_b32 s47, -1, s47
    s_sub_u32 s38, s38, 1
    ds_read_b64_tr_b16 v[80:81], v16 offset:0
    ds_read_b64_tr_b16 v[82:83], v16 offset:256
    v_mfma_f32_32x32x16_bf16 v[48:63], v[84:87], v[112:115], v[48:63]
    ds_read_b128 v[96:99], v12 offset:0
    ds_read_b128 v[100:103], v12 offset:4096
    s_branch K1_comp2
K1_tail2:
    ds_read_b32 v20, v18
    ds_read_b128 v[144:147], v17 offset:0
    ds_read_b128 v[148:151], v17 offset:512
    v_mfma_f32_32x32x16_bf16 v[32:47], v[84:87], v[108:111], v[32:47]
    v_cmp_gt_u32 vcc, 32, v0
    v_mov_b32 v21, 0
    v_mfma_f32_32x32x16_bf16 v[32:47], v[88:91], v[120:123], v[32:47]
    s_waitcnt lgkmcnt(0)
    v_cndmask_b32 v20, 0, v20, vcc
    v_mfma_f32_32x32x16_bf16 v[32:47], v[92:95], v[132:135], v[32:47]
    s_nop 0
    v_mfma_f32_32x32x8_bf16 v[32:47], v[20:21], v[144:145], v[32:47]
    v_mfma_f32_32x32x16_bf16 v[48:63], v[84:87], v[112:115], v[48:63]
    s_cmp_eq_u32 s44, 3
    v_mfma_f32_32x32x16_bf16 v[48:63], v[88:91], v[124:127], v[48:63]
    s_cbranch_scc1 K1_h2
    s_lshl_b32 s48, s36, 2
    s_add_u32 s48, s48, s33
    s_lshl_b32 s49, s48, 11
    s_mul_i32 s41, s54, 40960
    s_add_u32 s49, s49, s41
    s_add_u32 s42, s49, 40960
    s_lshl_b32 s48, s48, 5
    s_lshr_b32 s41, s54, 1
    s_add_u32 s48, s48, s41
    s_lshl_b32 s48, s48, 7
    s_add_u32 s64, s48, 16777216
    s_cmp_eq_u32 s36, 17
    v_mfma_f32_32x32x16_bf16 v[48:63], v[92:95], v[136:139], v[48:63]
    v_mul_f32 v32, v32, v147
    v_mul_f32 v33, v33, v147
    v_mul_f32 v34, v34, v147
    v_mul_f32 v35, v35, v147
    v_mul_f32 v36, v36, v147
    v_mul_f32 v37, v37, v147
    v_mul_f32 v38, v38, v147
    v_mul_f32 v39, v39, v147
    v_mfma_f32_32x32x8_bf16 v[48:63], v[20:21], v[148:149], v[48:63]
    v_mul_f32 v40, v40, v147
    v_mul_f32 v41, v41, v147
    v_mul_f32 v42, v42, v147
    v_mul_f32 v43, v43, v147
    v_mul_f32 v44, v44, v147
    v_mul_f32 v45, v45, v147
    v_mul_f32 v46, v46, v147
    v_mul_f32 v47, v47, v147
    v_cvt_pk_bf16_f32 v64, v32, v33
    v_cvt_pk_bf16_f32 v65, v34, v35
    v_cvt_pk_bf16_f32 v66, v36, v37
    v_cvt_pk_bf16_f32 v67, v38, v39
    v_cvt_pk_bf16_f32 v68, v40, v41
    v_cvt_pk_bf16_f32 v69, v42, v43
    v_cvt_pk_bf16_f32 v70, v44, v45
    v_cvt_pk_bf16_f32 v71, v46, v47
    s_cbranch_scc1 K1_kv
    buffer_store_dwordx4 v[64:67], v1, s[28:31], s49 offen sc1
    buffer_store_dwordx4 v[68:71], v1, s[28:31], s49 offen offset:1024 sc1
    v_mul_f32 v48, v48, v151
    v_mul_f32 v49, v49, v151
    v_mul_f32 v50, v50, v151
    v_mul_f32 v51, v51, v151
    v_mul_f32 v52, v52, v151
    v_mul_f32 v53, v53, v151
    v_mul_f32 v54, v54, v151
    v_mul_f32 v55, v55, v151
    v_mul_f32 v56, v56, v151
    v_mul_f32 v57, v57, v151
    v_mul_f32 v58, v58, v151
    v_mul_f32 v59, v59, v151
    v_mul_f32 v60, v60, v151
    v_mul_f32 v61, v61, v151
    v_mul_f32 v62, v62, v151
    v_mul_f32 v63, v63, v151
    v_cvt_pk_bf16_f32 v72, v48, v49
    v_cvt_pk_bf16_f32 v73, v50, v51
    v_cvt_pk_bf16_f32 v74, v52, v53
    v_cvt_pk_bf16_f32 v75, v54, v55
    v_cvt_pk_bf16_f32 v76, v56, v57
    v_cvt_pk_bf16_f32 v77, v58, v59
    v_cvt_pk_bf16_f32 v78, v60, v61
    v_cvt_pk_bf16_f32 v79, v62, v63
    buffer_store_dwordx4 v[72:75], v1, s[28:31], s42 offen sc1
    buffer_store_dwordx4 v[76:79], v1, s[28:31], s42 offen offset:1024 sc1
    v_mov_b32 v4, s68
    v_lshlrev_b32 v5, 8, v0
    s_mov_b64 exec, 1
    s_waitcnt vmcnt(0)
    buffer_store_dword v4, v5, s[28:31], s64 offen sc1
    s_mov_b64 exec, -1
    s_branch K2_A
K1_kv:
    v_mul_f32 v48, v48, v151
    v_mul_f32 v49, v49, v151
    v_mul_f32 v50, v50, v151
    v_mul_f32 v51, v51, v151
    v_mul_f32 v52, v52, v151
    v_mul_f32 v53, v53, v151
    v_mul_f32 v54, v54, v151
    v_mul_f32 v55, v55, v151
    v_mul_f32 v56, v56, v151
    v_mul_f32 v57, v57, v151
    v_mul_f32 v58, v58, v151
    v_mul_f32 v59, v59, v151
    v_cvt_pk_bf16_f32 v72, v48, v49
    v_cvt_pk_bf16_f32 v73, v50, v51
    v_cvt_pk_bf16_f32 v74, v52, v53
    v_cvt_pk_bf16_f32 v75, v54, v55
    v_cvt_pk_bf16_f32 v76, v56, v57
    v_cvt_pk_bf16_f32 v77, v58, v59
    s_mul_i32 s41, s35, 10240
    s_add_u32 s41, s41, 3145728
    s_bitcmp1_b32 s33, 0
    s_cbranch_scc1 K1_vst
    v_mul_u32_u24 v4, 5120, v24
    v_lshl_add_u32 v4, v10, 4, v4
    v_lshlrev_b32 v5, 4, v10
    s_lshl_b32 s42, s34, 10
    s_add_u32 s42, s42, s41
    buffer_store_dwordx4 v[64:67], v4, s[28:31], s42 offen sc1
    buffer_store_dwordx4 v[72:75], v4, s[28:31], s42 offen offset:512 sc1
    s_lshl_b32 s42, s34, 3
    s_add_u32 s41, s41, s42
    s_add_u32 s42, s41, 5120
    s_mov_b32 exec_lo, 0
    buffer_store_dwordx2 v[68:69], v5, s[28:31], s41 offen offset:2048 sc1
    buffer_store_dwordx2 v[76:77], v5, s[28:31], s42 offen offset:2048 sc1
    s_branch K1_done
K1_vst:
    s_lshl_b32 s49, s34, 12
    v_bfe_u32 v4, v10, 2, 1
    v_mul_u32_u24 v4, 1280, v4
    v_lshl_add_u32 v4, v24, 6, v4
    v_lshrrev_b32 v5, 4, v10
    v_mul_u32_u24 v5, 320, v5
    v_add_u32 v4, v4, v5
    v_bfe_u32 v5, v10, 3, 1
    v_lshl_add_u32 v4, v5, 3, v4
    v_and_b32 v5, 3, v10
    v_lshl_add_u32 v4, v5, 1, v4
    v_add_u32 v4, s49, v4
    v_add_u32 v5, s49, v1
    ds_write_b16 v4, v64 offset:0
    ds_write_b16_d16_hi v4, v64 offset:16
    ds_write_b16 v4, v65 offset:32
    ds_write_b16_d16_hi v4, v65 offset:48
    ds_write_b16 v4, v72 offset:640
    ds_write_b16_d16_hi v4, v72 offset:656
    ds_write_b16 v4, v73 offset:672
    ds_write_b16_d16_hi v4, v73 offset:688
    s_waitcnt lgkmcnt(4)
    ds_write_b16 v4, v66 offset:128
    ds_write_b16_d16_hi v4, v66 offset:144
    ds_write_b16 v4, v67 offset:160
    ds_write_b16_d16_hi v4, v67 offset:176
    ds_write_b16 v4, v74 offset:768
    ds_write_b16_d16_hi v4, v74 offset:784
    ds_write_b16 v4, v75 offset:800
    ds_write_b16_d16_hi v4, v75 offset:816
    s_waitcnt lgkmcnt(4)
    s_mov_b32 exec_lo, 0
    ds_write_b16 v4, v68 offset:192
    ds_write_b16_d16_hi v4, v68 offset:208
    ds_write_b16 v4, v69 offset:224
    ds_write_b16_d16_hi v4, v69 offset:240
    ds_write_b16 v4, v76 offset:832
    ds_write_b16_d16_hi v4, v76 offset:848
    ds_write_b16 v4, v77 offset:864
    ds_write_b16_d16_hi v4, v77 offset:880
    s_mul_i32 s42, s34, 1280
    s_add_u32 s41, s41, s42
    s_add_u32 s42, s41, 5120
    s_mov_b32 exec_lo, -1
    s_mov_b32 exec_hi, 0xff
    s_waitcnt lgkmcnt(0)
    ds_read_b128 v[32:35], v5 offset:0
    ds_read_b128 v[36:39], v5 offset:640
    ds_read_b128 v[40:43], v5 offset:1280
    ds_read_b128 v[44:47], v5 offset:1920
    s_waitcnt lgkmcnt(3)
    buffer_store_dwordx4 v[32:35], v1, s[28:31], s41 offen offset:2560 sc1
    s_waitcnt lgkmcnt(2)
    buffer_store_dwordx4 v[36:39], v1, s[28:31], s41 offen offset:3200 sc1
    s_waitcnt lgkmcnt(1)
    buffer_store_dwordx4 v[40:43], v1, s[28:31], s42 offen offset:2560 sc1
    s_waitcnt lgkmcnt(0)
    buffer_store_dwordx4 v[44:47], v1, s[28:31], s42 offen offset:3200 sc1
K1_done:
    s_mov_b64 exec, 1
    v_mov_b32 v4, 1
    s_waitcnt vmcnt(0)
    buffer_atomic_add v4, v3, s[20:23], 0 offen offset:128 sc0
    s_mov_b32 s52, 17170432
    s_waitcnt vmcnt(0)
    v_readfirstlane_b32 s41, v4
    s_mov_b64 exec, -1
    s_and_b32 s41, s41, 63
    s_cmp_lg_u32 s41, 63
    s_cbranch_scc1 K2_A
    v_mov_b32 v4, s68
    v_lshlrev_b32 v5, 7, v0
    buffer_store_dword v4, v5, s[28:31], s52 offen sc1
    s_add_u32 s52, s52, 8192
    s_branch K2_A
K1_idle:
    s_barrier
    s_sub_u32 s38, s38, 1
    s_cmp_lg_u32 s38, -2
    s_cbranch_scc1 K1_idle
    ds_read_b32 v4, v9
    s_waitcnt lgkmcnt(0)
    v_readfirstlane_b32 s68, v4
    s_branch K2_A
K1_aux:
    s_and_b32 s33, s32, 3
    s_mov_b32 s44, 0
    s_mov_b32 s36, 0
    s_mov_b32 s58, 0
    s_mov_b32 s22, 256
    s_mov_b32 s23, 0x00020000
    v_mov_b32 v5, 0
    s_mov_b32 s49, 0
    s_waitcnt lgkmcnt(0)
    s_mov_b32 s28, s6
    s_mov_b32 s29, s7
    s_mov_b32 s20, s4
    s_mov_b32 s21, s5
K1_a3:
    buffer_load_dword v4, v5, s[20:23], 0 offen sc1
    s_add_u32 s49, s49, 1
    s_waitcnt vmcnt(0)
    v_readfirstlane_b32 s68, v4
    s_cmp_gt_u32 s49, 200000
    s_cbranch_scc1 K1_a3x
    s_cmp_lg_u32 s68, 0
    s_cbranch_scc1 K1_a3x
    s_sleep 16
    s_branch K1_a3
K1_a3x:
    s_cmp_ge_u32 s32, 8
    s_cbranch_scc1 K1_pk
    s_and_b32 s96, s2, 3
    s_lshl_b32 s100, s96, 2
    s_bfe_u32 s96, s2, 0x20003
    s_add_u32 s100, s100, s96
    s_lshl_b32 s100, s100, 2
    s_and_b32 s98, s32, 3
    s_add_u32 s100, s100, s98
    s_bfe_u32 s96, s2, 0x10002
    s_lshl_b32 s99, s96, 1
    s_lshr_b32 s96, s2, 7
    s_add_u32 s99, s99, s96
    s_lshl_b32 s99, s99, 3
    s_bfe_u32 s97, s2, 0x20005
    s_add_u32 s99, s99, s97
    s_and_b32 s96, s32, 4
    s_add_u32 s99, s99, s96
    s_lshl_b32 s98, s98, 12
    s_lshl_b32 s96, s96, 9
    s_add_u32 s98, s98, s96
    s_add_u32 s98, s98, 147456
    v_lshlrev_b32 v2, 4, v0
    v_and_b32 v164, 31, v0
    v_lshlrev_b32 v164, 4, v164
    v_lshrrev_b32 v19, 5, v0
    v_add_u32 v165, s97, v19
    v_add_u32 v166, 2, v165
    s_add_u32 s96, s97, 4
    v_mov_b32 v167, s96
    v_lshrrev_b32 v22, 2, v165
    v_lshl_add_u32 v23, v22, 10, v164
    v_and_b32 v22, 1, v165
    v_lshl_add_u32 v23, v22, 9, v23
    v_and_b32 v22, 2, v165
    v_lshl_add_u32 v23, v22, 2, v23
    v_add_u32 v165, s98, v23
    v_lshrrev_b32 v22, 2, v166
    v_lshl_add_u32 v23, v22, 10, v164
    v_and_b32 v22, 1, v166
    v_lshl_add_u32 v23, v22, 9, v23
    v_and_b32 v22, 2, v166
    v_lshl_add_u32 v23, v22, 2, v23
    v_add_u32 v166, s98, v23
    v_lshrrev_b32 v22, 2, v167
    v_lshl_add_u32 v23, v22, 10, v164
    v_and_b32 v22, 1, v167
    v_lshl_add_u32 v23, v22, 9, v23
    v_and_b32 v22, 2, v167
    v_lshl_add_u32 v23, v22, 2, v23
    v_add_u32 v167, s98, v23
    v_mul_u32_u24 v19, 5120, v19
    v_add_u32 v164, v164, v19
    v_and_b32 v19, 27, v0
    v_cmp_eq_u32 vcc, 24, v19
    v_mov_b32 v19, 0x3f803f80
    s_mov_b32 s94, 0x000fffff
    s_mov_b32 s95, 0x000fffff
    v_cndmask_b32 v22, 0, v19, vcc
    v_cndmask_b32 v23, 0, v19, vcc
    s_lshr_b32 s90, s99, 2
    s_mul_i32 s90, s90, 5
    s_mul_i32 s91, s100, 40
    s_add_u32 s90, s90, s91
    s_lshl_b32 s90, s90, 10
    s_add_u32 s90, s90, 9699328
    s_lshl_b32 s91, s97, 10
    s_add_u32 s91, s91, s90
    s_lshr_b32 s98, s97, 1
    s_lshl_b32 s98, s98, 9
    s_add_u32 s90, s90, s98
    s_and_b32 s98, s97, 1
    s_lshl_b32 s98, s98, 3
    s_add_u32 s90, s90, s98
    s_add_u32 s90, s90, 4096
    s_lshl_b32 s92, s100, 5
    s_add_u32 s92, s92, s99
    s_lshl_b32 s92, s92, 7
    s_add_u32 s92, s92, 17301504
    s_branch K2_A
K1_h2:
    s_lshl_b32 s49, s33, 10
    s_mul_i32 s41, s34, 24576
    s_add_u32 s49, s49, s41
    s_add_u32 s49, s49, 65536
    v_add_u32 v1, s49, v1
    s_nop 5
    v_mfma_f32_32x32x16_bf16 v[48:63], v[92:95], v[136:139], v[48:63]
    v_mul_f32 v96, v32, v147
    v_mul_f32 v97, v33, v147
    v_mul_f32 v98, v34, v147
    v_mul_f32 v99, v35, v147
    v_mul_f32 v100, v36, v147
    v_mul_f32 v101, v37, v147
    v_mul_f32 v102, v38, v147
    v_mul_f32 v103, v39, v147
    v_mul_f32 v104, v40, v147
    v_mul_f32 v105, v41, v147
    v_mul_f32 v106, v42, v147
    v_mul_f32 v107, v43, v147
    v_mul_f32 v108, v44, v147
    v_mul_f32 v109, v45, v147
    v_mul_f32 v110, v46, v147
    v_mul_f32 v111, v47, v147
    v_exp_f32 v96, v96
    v_exp_f32 v97, v97
    v_mfma_f32_32x32x8_bf16 v[48:63], v[20:21], v[148:149], v[48:63]
    v_exp_f32 v98, v98
    v_exp_f32 v99, v99
    v_exp_f32 v100, v100
    v_exp_f32 v101, v101
    v_exp_f32 v102, v102
    v_exp_f32 v103, v103
    v_exp_f32 v104, v104
    v_exp_f32 v105, v105
    v_exp_f32 v106, v106
    v_exp_f32 v107, v107
    v_exp_f32 v108, v108
    v_exp_f32 v109, v109
    v_exp_f32 v110, v110
    v_exp_f32 v111, v111
    v_fma_f32 v96, v96, v146, v146
    v_fma_f32 v97, v97, v146, v146
    v_fma_f32 v98, v98, v146, v146
    v_fma_f32 v99, v99, v146, v146
    s_branch K1_h3
K1_start3:
    ds_read_b64_tr_b16 v[80:81], v16 offset:0
    ds_read_b64_tr_b16 v[82:83], v16 offset:256
    ds_read_b128 v[96:99], v12 offset:0
    ds_read_b128 v[100:103], v12 offset:4096
    ds_read_b128 v[104:107], v12 offset:8192
    ds_read_b64_tr_b16 v[84:85], v16 offset:2048
    ds_read_b64_tr_b16 v[86:87], v16 offset:2304
    ds_read_b128 v[108:111], v13 offset:0
    ds_read_b128 v[112:115], v13 offset:4096
    ds_read_b128 v[116:119], v13 offset:8192
    ds_read_b64_tr_b16 v[88:89], v16 offset:4096
    ds_read_b64_tr_b16 v[90:91], v16 offset:4352
    ds_read_b128 v[120:123], v14 offset:0
    ds_read_b128 v[124:127], v14 offset:4096
    ds_read_b128 v[128:131], v14 offset:8192
    v_add_u32 v12, s46, v12
    v_add_u32 v13, s46, v13
    s_mov_b32 s41, 0
K1_n3:
    s_waitcnt vmcnt(0)
    v_readfirstlane_b32 s68, v161
    s_add_u32 s41, s41, 1
    s_cmp_lg_u32 s68, 0
    s_cbranch_scc1 K1_n3x
    buffer_load_dword v161, v3, s[20:23], 0 offen sc1
    s_cmp_lt_u32 s41, 200000
    s_cbranch_scc1 K1_n3
K1_n3x:
    v_mov_b32 v163, v161
    v_mov_b32 v21, v161
    s_mov_b32 exec_hi, 0
    buffer_store_dwordx4 v[160:163], v1, s[28:31], s48 offen sc1
    s_waitcnt lgkmcnt(0)
    ds_write_b32 v9, v161
    s_mov_b32 exec_hi, -1
    s_branch K1_mid3
K1_comp3:
    v_mfma_f32_32x32x16_bf16 v[32:47], v[88:91], v[120:123], v[32:47]
    ds_read_b64_tr_b16 v[84:85], v16 offset:2048
    v_mfma_f32_32x32x16_bf16 v[48:63], v[88:91], v[124:127], v[48:63]
    ds_read_b64_tr_b16 v[86:87], v16 offset:2304
    ds_read_b128 v[108:111], v13 offset:0
    v_mfma_f32_32x32x16_bf16 v[64:79], v[88:91], v[128:131], v[64:79]
    ds_read_b128 v[112:115], v13 offset:4096
    ds_read_b128 v[116:119], v13 offset:8192
    v_add_u32 v12, s46, v12
    v_mfma_f32_32x32x16_bf16 v[32:47], v[92:95], v[132:135], v[32:47]
    ds_read_b64_tr_b16 v[88:89], v16 offset:4096
    v_mfma_f32_32x32x16_bf16 v[48:63], v[92:95], v[136:139], v[48:63]
    ds_read_b64_tr_b16 v[90:91], v16 offset:4352
    ds_read_b128 v[120:123], v14 offset:0
    v_mfma_f32_32x32x16_bf16 v[64:79], v[92:95], v[140:143], v[64:79]
    ds_read_b128 v[124:127], v14 offset:4096
    ds_read_b128 v[128:131], v14 offset:8192
    v_add_u32 v13, s46, v13
K1_mid3:
    s_waitcnt lgkmcnt(10)
    ds_read_b64_tr_b16 v[92:93], v16 offset:6144
    ds_read_b64_tr_b16 v[94:95], v16 offset:6400
    v_mfma_f32_32x32x16_bf16 v[32:47], v[80:83], v[96:99], v[32:47]
    ds_read_b128 v[132:135], v15 offset:0
    ds_read_b128 v[136:139], v15 offset:4096
    ds_read_b128 v[140:143], v15 offset:8192
    v_add_u32 v14, s46, v14
    v_mfma_f32_32x32x16_bf16 v[48:63], v[80:83], v[100:103], v[48:63]
    v_mfma_f32_32x32x16_bf16 v[64:79], v[80:83], v[104:107], v[64:79]
    v_add_u32 v15, s46, v15
    v_add_u32 v16, s46, v16
    s_cmp_eq_u32 s38, 0
    s_waitcnt lgkmcnt(0)
    s_barrier
    s_cbranch_scc1 K1_tail3
    v_mfma_f32_32x32x16_bf16 v[32:47], v[84:87], v[108:111], v[32:47]
    s_add_u32 s47, s47, 1
    s_cmp_eq_u32 s47, 2
    s_mov_b32 s46, 40960
    s_cselect_b32 s46, 4294885376, s46
    s_cselect_b32 s47, -1, s47
    s_sub_u32 s38, s38, 1
    ds_read_b64_tr_b16 v[80:81], v16 offset:0
    v_mfma_f32_32x32x16_bf16 v[48:63], v[84:87], v[112:115], v[48:63]
    ds_read_b64_tr_b16 v[82:83], v16 offset:256
    ds_read_b128 v[96:99], v12 offset:0
    v_mfma_f32_32x32x16_bf16 v[64:79], v[84:87], v[116:119], v[64:79]
    ds_read_b128 v[100:103], v12 offset:4096
    ds_read_b128 v[104:107], v12 offset:8192
    s_branch K1_comp3
K1_tail3:
    ds_read_b32 v20, v18
    ds_read_b128 v[144:147], v17 offset:0
    ds_read_b128 v[148:151], v17 offset:512
    ds_read_b128 v[152:155], v17 offset:1024
    v_mfma_f32_32x32x16_bf16 v[32:47], v[84:87], v[108:111], v[32:47]
    v_cmp_gt_u32 vcc, 32, v0
    v_mov_b32 v21, 0
    v_mfma_f32_32x32x16_bf16 v[32:47], v[88:91], v[120:123], v[32:47]
    s_waitcnt lgkmcnt(0)
    v_cndmask_b32 v20, 0, v20, vcc
    v_mfma_f32_32x32x16_bf16 v[32:47], v[92:95], v[132:135], v[32:47]
    s_nop 0
    v_mfma_f32_32x32x8_bf16 v[32:47], v[20:21], v[144:145], v[32:47]
    v_mfma_f32_32x32x16_bf16 v[48:63], v[84:87], v[112:115], v[48:63]
    v_mfma_f32_32x32x16_bf16 v[48:63], v[88:91], v[124:127], v[48:63]
    s_lshl_b32 s49, s33, 10
    s_mul_i32 s41, s34, 24576
    s_add_u32 s49, s49, s41
    s_add_u32 s49, s49, 65536
    v_add_u32 v1, s49, v1
    s_nop 5
    v_mfma_f32_32x32x16_bf16 v[48:63], v[92:95], v[136:139], v[48:63]
    v_mul_f32 v96, v32, v147
    v_mul_f32 v97, v33, v147
    v_mul_f32 v98, v34, v147
    v_mul_f32 v99, v35, v147
    v_mul_f32 v100, v36, v147
    v_mul_f32 v101, v37, v147
    v_mfma_f32_32x32x8_bf16 v[48:63], v[20:21], v[148:149], v[48:63]
    v_mul_f32 v102, v38, v147
    v_mul_f32 v103, v39, v147
    v_mul_f32 v104, v40, v147
    v_mul_f32 v105, v41, v147
    v_mul_f32 v106, v42, v147
    v_mul_f32 v107, v43, v147
    v_mfma_f32_32x32x16_bf16 v[64:79], v[84:87], v[116:119], v[64:79]
    v_mul_f32 v108, v44, v147
    v_mul_f32 v109, v45, v147
    v_mul_f32 v110, v46, v147
    v_mul_f32 v111, v47, v147
    v_exp_f32 v96, v96
    v_exp_f32 v97, v97
    v_mfma_f32_32x32x16_bf16 v[64:79], v[88:91], v[128:131], v[64:79]
    v_exp_f32 v98, v98
    v_exp_f32 v99, v99
    v_exp_f32 v100, v100
    v_exp_f32 v101, v101
    v_exp_f32 v102, v102
    v_exp_f32 v103, v103
    v_mfma_f32_32x32x16_bf16 v[64:79], v[92:95], v[140:143], v[64:79]
    v_exp_f32 v104, v104
    v_exp_f32 v105, v105
    v_exp_f32 v106, v106
    v_exp_f32 v107, v107
    v_exp_f32 v108, v108
    v_exp_f32 v109, v109
    v_mfma_f32_32x32x8_bf16 v[64:79], v[20:21], v[152:153], v[64:79]
    v_exp_f32 v110, v110
    v_exp_f32 v111, v111
    v_fma_f32 v96, v96, v146, v146
    v_fma_f32 v97, v97, v146, v146
    v_fma_f32 v98, v98, v146, v146
    v_fma_f32 v99, v99, v146, v146
K1_h3:
    v_fma_f32 v100, v100, v146, v146
    v_fma_f32 v101, v101, v146, v146
    v_fma_f32 v102, v102, v146, v146
    v_fma_f32 v103, v103, v146, v146
    v_fma_f32 v104, v104, v146, v146
    v_fma_f32 v105, v105, v146, v146
    v_fma_f32 v106, v106, v146, v146
    v_fma_f32 v107, v107, v146, v146
    v_fma_f32 v108, v108, v146, v146
    v_fma_f32 v109, v109, v146, v146
    v_fma_f32 v110, v110, v146, v146
    v_fma_f32 v111, v111, v146, v146
    v_rcp_f32 v96, v96
    v_rcp_f32 v97, v97
    v_rcp_f32 v98, v98
    v_rcp_f32 v99, v99
    v_rcp_f32 v100, v100
    v_rcp_f32 v101, v101
    v_rcp_f32 v102, v102
    v_rcp_f32 v103, v103
    v_rcp_f32 v104, v104
    v_rcp_f32 v105, v105
    v_rcp_f32 v106, v106
    v_rcp_f32 v107, v107
    v_rcp_f32 v108, v108
    v_rcp_f32 v109, v109
    v_rcp_f32 v110, v110
    v_rcp_f32 v111, v111
    v_mul_f32 v96, v96, v32
    v_mul_f32 v97, v97, v33
    v_mul_f32 v98, v98, v34
    v_mul_f32 v99, v99, v35
    v_mul_f32 v100, v100, v36
    v_mul_f32 v101, v101, v37
    v_mul_f32 v102, v102, v38
    v_mul_f32 v103, v103, v39
    v_mul_f32 v104, v104, v40
    v_mul_f32 v105, v105, v41
    v_mul_f32 v106, v106, v42
    v_mul_f32 v107, v107, v43
    v_mul_f32 v108, v108, v44
    v_mul_f32 v109, v109, v45
    v_mul_f32 v110, v110, v46
    v_mul_f32 v111, v111, v47
    v_cvt_pk_bf16_f32 v156, v96, v97
    v_cvt_pk_bf16_f32 v157, v98, v99
    v_cvt_pk_bf16_f32 v158, v100, v101
    v_cvt_pk_bf16_f32 v159, v102, v103
    v_cvt_pk_bf16_f32 v160, v104, v105
    v_cvt_pk_bf16_f32 v161, v106, v107
    v_cvt_pk_bf16_f32 v162, v108, v109
    v_cvt_pk_bf16_f32 v163, v110, v111
    ds_write_b128 v1, v[156:159] offset:0
    ds_write_b128 v1, v[160:163] offset:4096
    v_pk_mul_f32 v[96:97], v[48:49], v[150:151] op_sel:[0,1] op_sel_hi:[1,1]
    v_pk_mul_f32 v[98:99], v[50:51], v[150:151] op_sel:[0,1] op_sel_hi:[1,1]
    v_pk_mul_f32 v[100:101], v[52:53], v[150:151] op_sel:[0,1] op_sel_hi:[1,1]
    v_pk_mul_f32 v[102:103], v[54:55], v[150:151] op_sel:[0,1] op_sel_hi:[1,1]
    v_pk_mul_f32 v[104:105], v[56:57], v[150:151] op_sel:[0,1] op_sel_hi:[1,1]
    v_pk_mul_f32 v[106:107], v[58:59], v[150:151] op_sel:[0,1] op_sel_hi:[1,1]
    v_pk_mul_f32 v[108:109], v[60:61], v[150:151] op_sel:[0,1] op_sel_hi:[1,1]
    v_pk_mul_f32 v[110:111], v[62:63], v[150:151] op_sel:[0,1] op_sel_hi:[1,1]
    v_exp_f32 v96, v96
    v_exp_f32 v97, v97
    v_exp_f32 v98, v98
    v_exp_f32 v99, v99
    v_exp_f32 v100, v100
    v_exp_f32 v101, v101
    v_exp_f32 v102, v102
    v_exp_f32 v103, v103
    v_exp_f32 v104, v104
    v_exp_f32 v105, v105
    v_exp_f32 v106, v106
    v_exp_f32 v107, v107
    v_exp_f32 v108, v108
    v_exp_f32 v109, v109
    v_exp_f32 v110, v110
    v_exp_f32 v111, v111
    v_pk_fma_f32 v[96:97], v[96:97], v[150:151], v[150:151] op_sel_hi:[1,0,0]
    v_pk_fma_f32 v[98:99], v[98:99], v[150:151], v[150:151] op_sel_hi:[1,0,0]
    v_pk_fma_f32 v[100:101], v[100:101], v[150:151], v[150:151] op_sel_hi:[1,0,0]
    v_pk_fma_f32 v[102:103], v[102:103], v[150:151], v[150:151] op_sel_hi:[1,0,0]
    v_pk_fma_f32 v[104:105], v[104:105], v[150:151], v[150:151] op_sel_hi:[1,0,0]
    v_pk_fma_f32 v[106:107], v[106:107], v[150:151], v[150:151] op_sel_hi:[1,0,0]
    v_pk_fma_f32 v[108:109], v[108:109], v[150:151], v[150:151] op_sel_hi:[1,0,0]
    v_pk_fma_f32 v[110:111], v[110:111], v[150:151], v[150:151] op_sel_hi:[1,0,0]
    v_rcp_f32 v96, v96
    v_rcp_f32 v97, v97
    v_rcp_f32 v98, v98
    v_rcp_f32 v99, v99
    v_rcp_f32 v100, v100
    v_rcp_f32 v101, v101
    v_rcp_f32 v102, v102
    v_rcp_f32 v103, v103
    v_rcp_f32 v104, v104
    v_rcp_f32 v105, v105
    v_rcp_f32 v106, v106
    v_rcp_f32 v107, v107
    v_rcp_f32 v108, v108
    v_rcp_f32 v109, v109
    v_rcp_f32 v110, v110
    v_rcp_f32 v111, v111
    v_pk_mul_f32 v[96:97], v[96:97], v[48:49]
    v_pk_mul_f32 v[98:99], v[98:99], v[50:51]
    v_pk_mul_f32 v[100:101], v[100:101], v[52:53]
    v_pk_mul_f32 v[102:103], v[102:103], v[54:55]
    v_pk_mul_f32 v[104:105], v[104:105], v[56:57]
    v_pk_mul_f32 v[106:107], v[106:107], v[58:59]
    v_pk_mul_f32 v[108:109], v[108:109], v[60:61]
    v_pk_mul_f32 v[110:111], v[110:111], v[62:63]
    v_cvt_pk_bf16_f32 v156, v96, v97
    v_cvt_pk_bf16_f32 v157, v98, v99
    v_cvt_pk_bf16_f32 v158, v100, v101
    v_cvt_pk_bf16_f32 v159, v102, v103
    v_cvt_pk_bf16_f32 v160, v104, v105
    v_cvt_pk_bf16_f32 v161, v106, v107
    v_cvt_pk_bf16_f32 v162, v108, v109
    v_cvt_pk_bf16_f32 v163, v110, v111
    ds_write_b128 v1, v[156:159] offset:8192
    ds_write_b128 v1, v[160:163] offset:12288
    s_cmp_lg_u32 s34, 0
    s_cbranch_scc1 K1_h4
    v_pk_mul_f32 v[96:97], v[64:65], v[154:155] op_sel:[0,1] op_sel_hi:[1,1]
    v_pk_mul_f32 v[98:99], v[66:67], v[154:155] op_sel:[0,1] op_sel_hi:[1,1]
    v_pk_mul_f32 v[100:101], v[68:69], v[154:155] op_sel:[0,1] op_sel_hi:[1,1]
    v_pk_mul_f32 v[102:103], v[70:71], v[154:155] op_sel:[0,1] op_sel_hi:[1,1]
    v_pk_mul_f32 v[104:105], v[72:73], v[154:155] op_sel:[0,1] op_sel_hi:[1,1]
    v_pk_mul_f32 v[106:107], v[74:75], v[154:155] op_sel:[0,1] op_sel_hi:[1,1]
    v_pk_mul_f32 v[108:109], v[76:77], v[154:155] op_sel:[0,1] op_sel_hi:[1,1]
    v_pk_mul_f32 v[110:111], v[78:79], v[154:155] op_sel:[0,1] op_sel_hi:[1,1]
    v_exp_f32 v96, v96
    v_exp_f32 v97, v97
    v_exp_f32 v98, v98
    v_exp_f32 v99, v99
    v_exp_f32 v100, v100
    v_exp_f32 v101, v101
    v_exp_f32 v102, v102
    v_exp_f32 v103, v103
    v_exp_f32 v104, v104
    v_exp_f32 v105, v105
    v_exp_f32 v106, v106
    v_exp_f32 v107, v107
    v_exp_f32 v108, v108
    v_exp_f32 v109, v109
    v_exp_f32 v110, v110
    v_exp_f32 v111, v111
    v_pk_fma_f32 v[96:97], v[96:97], v[154:155], v[154:155] op_sel_hi:[1,0,0]
    v_pk_fma_f32 v[98:99], v[98:99], v[154:155], v[154:155] op_sel_hi:[1,0,0]
    v_pk_fma_f32 v[100:101], v[100:101], v[154:155], v[154:155] op_sel_hi:[1,0,0]
    v_pk_fma_f32 v[102:103], v[102:103], v[154:155], v[154:155] op_sel_hi:[1,0,0]
    v_pk_fma_f32 v[104:105], v[104:105], v[154:155], v[154:155] op_sel_hi:[1,0,0]
    v_pk_fma_f32 v[106:107], v[106:107], v[154:155], v[154:155] op_sel_hi:[1,0,0]
    v_pk_fma_f32 v[108:109], v[108:109], v[154:155], v[154:155] op_sel_hi:[1,0,0]
    v_pk_fma_f32 v[110:111], v[110:111], v[154:155], v[154:155] op_sel_hi:[1,0,0]
    v_rcp_f32 v96, v96
    v_rcp_f32 v97, v97
    v_rcp_f32 v98, v98
    v_rcp_f32 v99, v99
    v_rcp_f32 v100, v100
    v_rcp_f32 v101, v101
    v_rcp_f32 v102, v102
    v_rcp_f32 v103, v103
    v_rcp_f32 v104, v104
    v_rcp_f32 v105, v105
    v_rcp_f32 v106, v106
    v_rcp_f32 v107, v107
    v_rcp_f32 v108, v108
    v_rcp_f32 v109, v109
    v_rcp_f32 v110, v110
    v_rcp_f32 v111, v111
    v_pk_mul_f32 v[96:97], v[96:97], v[64:65]
    v_pk_mul_f32 v[98:99], v[98:99], v[66:67]
    v_pk_mul_f32 v[100:101], v[100:101], v[68:69]
    v_pk_mul_f32 v[102:103], v[102:103], v[70:71]
    v_pk_mul_f32 v[104:105], v[104:105], v[72:73]
    v_pk_mul_f32 v[106:107], v[106:107], v[74:75]
    v_pk_mul_f32 v[108:109], v[108:109], v[76:77]
    v_pk_mul_f32 v[110:111], v[110:111], v[78:79]
    v_cvt_pk_bf16_f32 v156, v96, v97
    v_cvt_pk_bf16_f32 v157, v98, v99
    v_cvt_pk_bf16_f32 v158, v100, v101
    v_cvt_pk_bf16_f32 v159, v102, v103
    v_cvt_pk_bf16_f32 v160, v104, v105
    v_cvt_pk_bf16_f32 v161, v106, v107
    v_cvt_pk_bf16_f32 v162, v108, v109
    v_cvt_pk_bf16_f32 v163, v110, v111
    ds_write_b128 v1, v[156:159] offset:16384
    ds_write_b128 v1, v[160:163] offset:20480
K1_h4:
K2_A:
    v_mov_b64 v[52:53], 0
    v_mov_b64 v[54:55], 0
    v_mov_b64 v[24:25], v[22:23]
    v_mov_b64 v[26:27], v[22:23]
    v_mov_b64 v[28:29], v[22:23]
    v_mov_b64 v[30:31], v[22:23]
    v_mov_b64 v[32:33], v[22:23]
    v_mov_b64 v[34:35], v[22:23]
    v_mov_b64 v[36:37], v[22:23]
    v_mov_b64 v[38:39], v[22:23]
    v_mfma_f32_32x32x16_bf16 v[56:71], v[52:55], v[52:55], 0
    s_lshr_b32 s34, s32, 2
    s_mov_b32 s52, 73
    s_mov_b32 s39, 3
    s_waitcnt lgkmcnt(0)
    s_barrier
    ds_read_b64 v[8:9], v167
    ds_read_b128 v[20:23], v164 offset:2048
    ds_read_b64 v[4:5], v165
    ds_read_b64 v[6:7], v166
    ds_read_b128 v[12:15], v164 offset:0
    ds_read_b128 v[16:19], v164 offset:512
    s_waitcnt lgkmcnt(4)
    v_mfma_f32_32x32x4_2b_bf16 v[72:103], v[20:21], v[8:9], 0
    s_waitcnt lgkmcnt(0)
    s_nop 15
    s_nop 0
    v_mfma_f32_32x32x16_bf16 v[72:87], v[12:15], v[4:7], v[72:87]
    v_mfma_f32_32x32x16_bf16 v[88:103], v[16:19], v[4:7], v[88:103]
    ds_read_b128 v[12:15], v164 offset:1024
    ds_read_b128 v[16:19], v164 offset:1536
    s_mov_b64 exec, s[94:95]
    ds_read_b128 v[24:27], v164 offset:2560
    ds_read_b128 v[28:31], v164 offset:2880
    s_mov_b64 exec, -1
    s_nop 3
    .p2align 6
K2_loop:
    v_mfma_f32_32x32x4_2b_bf16 v[104:135], v[22:23], v[8:9], 0
    s_setprio 3
    v_exp_f32 v72, v72
    v_exp_f32 v73, v73
    v_exp_f32 v74, v74
    v_exp_f32 v75, v75
    v_exp_f32 v76, v76
    v_exp_f32 v77, v77
    v_cvt_pk_bf16_f32 v40, v72, v73
    v_exp_f32 v78, v78
    v_exp_f32 v79, v79
    v_cvt_pk_bf16_f32 v41, v74, v75
    v_mfma_f32_32x32x16_bf16 v[56:71], v[36:39], v[52:55], v[56:71]
    s_mov_b64 exec, s[94:95]
    ds_read_b128 v[32:35], v164 offset:3200
    ds_read_b128 v[36:39], v164 offset:3520
    s_mov_b64 exec, -1
    ds_read_b128 v[20:23], v164 offset:12288
    v_cvt_pk_bf16_f32 v42, v76, v77
    v_cvt_pk_bf16_f32 v43, v78, v79
    v_exp_f32 v80, v80
    v_exp_f32 v81, v81
    v_exp_f32 v82, v82
    v_exp_f32 v83, v83
    s_waitcnt lgkmcnt(3)
    v_mfma_f32_32x32x16_bf16 v[56:71], v[24:27], v[40:43], v[56:71]
    v_exp_f32 v84, v84
    v_exp_f32 v85, v85
    v_cvt_pk_bf16_f32 v44, v80, v81
    v_exp_f32 v86, v86
    v_exp_f32 v87, v87
    v_cvt_pk_bf16_f32 v45, v82, v83
    v_mfma_f32_32x32x16_bf16 v[104:119], v[12:15], v[4:7], v[104:119]
    v_cvt_pk_bf16_f32 v46, v84, v85
    v_cvt_pk_bf16_f32 v47, v86, v87
    v_exp_f32 v88, v88
    v_exp_f32 v89, v89
    v_exp_f32 v90, v90
    v_exp_f32 v91, v91
    v_mfma_f32_32x32x16_bf16 v[56:71], v[28:31], v[44:47], v[56:71]
    v_exp_f32 v92, v92
    v_exp_f32 v93, v93
    v_cvt_pk_bf16_f32 v48, v88, v89
    v_exp_f32 v94, v94
    v_exp_f32 v95, v95
    v_cvt_pk_bf16_f32 v49, v90, v91
    v_mfma_f32_32x32x16_bf16 v[120:135], v[16:19], v[4:7], v[120:135]
    ds_read_b128 v[12:15], v164 offset:10240
    ds_read_b128 v[16:19], v164 offset:10752
    s_mov_b64 exec, s[94:95]
    ds_read_b128 v[24:27], v164 offset:3840
    ds_read_b128 v[28:31], v164 offset:4160
    s_mov_b64 exec, -1
    v_cvt_pk_bf16_f32 v50, v92, v93
    v_cvt_pk_bf16_f32 v51, v94, v95
    v_exp_f32 v96, v96
    v_exp_f32 v97, v97
    v_exp_f32 v98, v98
    v_exp_f32 v99, v99
    s_waitcnt lgkmcnt(4)
    v_mfma_f32_32x32x16_bf16 v[56:71], v[32:35], v[48:51], v[56:71]
    v_exp_f32 v100, v100
    v_exp_f32 v101, v101
    v_cvt_pk_bf16_f32 v52, v96, v97
    v_exp_f32 v102, v102
    v_exp_f32 v103, v103
    v_cvt_pk_bf16_f32 v53, v98, v99
    v_cvt_pk_bf16_f32 v54, v100, v101
    v_cvt_pk_bf16_f32 v55, v102, v103
    v_mfma_f32_32x32x4_2b_bf16 v[72:103], v[20:21], v[8:9], 0
    v_exp_f32 v104, v104
    v_exp_f32 v105, v105
    v_exp_f32 v106, v106
    v_exp_f32 v107, v107
    v_exp_f32 v108, v108
    v_exp_f32 v109, v109
    v_cvt_pk_bf16_f32 v40, v104, v105
    v_exp_f32 v110, v110
    v_exp_f32 v111, v111
    v_cvt_pk_bf16_f32 v41, v106, v107
    v_mfma_f32_32x32x16_bf16 v[56:71], v[36:39], v[52:55], v[56:71]
    s_mov_b64 exec, s[94:95]
    ds_read_b128 v[32:35], v164 offset:4480
    ds_read_b128 v[36:39], v164 offset:4800
    s_mov_b64 exec, -1
    v_cvt_pk_bf16_f32 v42, v108, v109
    v_cvt_pk_bf16_f32 v43, v110, v111
    v_exp_f32 v112, v112
    v_exp_f32 v113, v113
    v_exp_f32 v114, v114
    v_exp_f32 v115, v115
    s_waitcnt lgkmcnt(2)
    v_mfma_f32_32x32x16_bf16 v[56:71], v[24:27], v[40:43], v[56:71]
    v_exp_f32 v116, v116
    v_exp_f32 v117, v117
    v_cvt_pk_bf16_f32 v44, v112, v113
    v_exp_f32 v118, v118
    v_exp_f32 v119, v119
    v_cvt_pk_bf16_f32 v45, v114, v115
    v_mfma_f32_32x32x16_bf16 v[72:87], v[12:15], v[4:7], v[72:87]
    s_setprio 2
    v_cvt_pk_bf16_f32 v46, v116, v117
    v_cvt_pk_bf16_f32 v47, v118, v119
    v_exp_f32 v120, v120
    v_exp_f32 v121, v121
    v_exp_f32 v122, v122
    v_exp_f32 v123, v123
    v_mfma_f32_32x32x16_bf16 v[56:71], v[28:31], v[44:47], v[56:71]
    v_exp_f32 v124, v124
    v_exp_f32 v125, v125
    v_cvt_pk_bf16_f32 v48, v120, v121
    v_exp_f32 v126, v126
    v_exp_f32 v127, v127
    v_cvt_pk_bf16_f32 v49, v122, v123
    v_mfma_f32_32x32x16_bf16 v[88:103], v[16:19], v[4:7], v[88:103]
    ds_read_b128 v[12:15], v164 offset:11264
    ds_read_b128 v[16:19], v164 offset:11776
    s_mov_b64 exec, s[94:95]
    ds_read_b128 v[24:27], v164 offset:12800
    ds_read_b128 v[28:31], v164 offset:13120
    s_mov_b64 exec, -1
    s_setprio 1
    v_cvt_pk_bf16_f32 v50, v124, v125
    v_cvt_pk_bf16_f32 v51, v126, v127
    v_exp_f32 v128, v128
    v_exp_f32 v129, v129
    v_exp_f32 v130, v130
    v_exp_f32 v131, v131
    s_waitcnt lgkmcnt(4)
    v_mfma_f32_32x32x16_bf16 v[56:71], v[32:35], v[48:51], v[56:71]
    v_exp_f32 v132, v132
    v_exp_f32 v133, v133
    v_cvt_pk_bf16_f32 v52, v128, v129
    v_exp_f32 v134, v134
    v_exp_f32 v135, v135
    v_cvt_pk_bf16_f32 v53, v130, v131
    v_cvt_pk_bf16_f32 v54, v132, v133
    v_cvt_pk_bf16_f32 v55, v134, v135
    v_add_u32 v164, 10240, v164
    s_sub_u32 s39, s39, 1
    s_cmp_lg_u32 s39, 0
    s_cbranch_scc1 K2_loop
    s_and_b32 s39, s52, 15
    s_lshr_b32 s52, s52, 4
    s_barrier
    s_cbranch_scc1 K2_loop
    v_mov_b64 v[136:137], -1
    v_mov_b64 v[138:139], -1
    buffer_store_dwordx4 v[136:139], v2, s[28:31], s91 offen sc1
    s_mov_b32 exec_hi, 0
    buffer_store_dwordx2 v[136:137], v2, s[28:31], s90 offen sc1
    s_mov_b32 exec_hi, -1
    s_setprio 1
    s_cmp_lg_u32 s34, 0
    s_cbranch_scc1 K2_loop2
    s_setprio 2
K2_loop2:
    v_mfma_f32_32x32x4_2b_bf16 v[104:135], v[22:23], v[8:9], 0
    v_exp_f32 v72, v72
    v_exp_f32 v73, v73
    v_exp_f32 v74, v74
    v_exp_f32 v75, v75
    v_exp_f32 v76, v76
    v_exp_f32 v77, v77
    v_cvt_pk_bf16_f32 v40, v72, v73
    v_exp_f32 v78, v78
    v_exp_f32 v79, v79
    v_cvt_pk_bf16_f32 v41, v74, v75
    v_mfma_f32_32x32x16_bf16 v[56:71], v[36:39], v[52:55], v[56:71]
    s_mov_b64 exec, s[94:95]
    ds_read_b128 v[32:35], v164 offset:3200
    ds_read_b128 v[36:39], v164 offset:3520
    s_mov_b64 exec, -1
    ds_read_b128 v[20:23], v164 offset:12288
    v_cvt_pk_bf16_f32 v42, v76, v77
    v_cvt_pk_bf16_f32 v43, v78, v79
    v_exp_f32 v80, v80
    v_exp_f32 v81, v81
    v_exp_f32 v82, v82
    v_exp_f32 v83, v83
    s_waitcnt lgkmcnt(3)
    v_mfma_f32_32x32x16_bf16 v[56:71], v[24:27], v[40:43], v[56:71]
    v_exp_f32 v84, v84
    v_exp_f32 v85, v85
    v_cvt_pk_bf16_f32 v44, v80, v81
    v_exp_f32 v86, v86
    v_exp_f32 v87, v87
    v_cvt_pk_bf16_f32 v45, v82, v83
    v_mfma_f32_32x32x16_bf16 v[104:119], v[12:15], v[4:7], v[104:119]
    v_cvt_pk_bf16_f32 v46, v84, v85
    v_cvt_pk_bf16_f32 v47, v86, v87
    v_exp_f32 v88, v88
    v_exp_f32 v89, v89
    v_exp_f32 v90, v90
    v_exp_f32 v91, v91
    v_mfma_f32_32x32x16_bf16 v[56:71], v[28:31], v[44:47], v[56:71]
    v_exp_f32 v92, v92
    v_exp_f32 v93, v93
    v_cvt_pk_bf16_f32 v48, v88, v89
    v_exp_f32 v94, v94
    v_exp_f32 v95, v95
    v_cvt_pk_bf16_f32 v49, v90, v91
    v_mfma_f32_32x32x16_bf16 v[120:135], v[16:19], v[4:7], v[120:135]
    ds_read_b128 v[12:15], v164 offset:10240
    ds_read_b128 v[16:19], v164 offset:10752
    s_mov_b64 exec, s[94:95]
    ds_read_b128 v[24:27], v164 offset:3840
    ds_read_b128 v[28:31], v164 offset:4160
    s_mov_b64 exec, -1
    v_cvt_pk_bf16_f32 v50, v92, v93
    v_cvt_pk_bf16_f32 v51, v94, v95
    v_exp_f32 v96, v96
    v_exp_f32 v97, v97
    v_exp_f32 v98, v98
    v_exp_f32 v99, v99
    s_waitcnt lgkmcnt(4)
    v_mfma_f32_32x32x16_bf16 v[56:71], v[32:35], v[48:51], v[56:71]
    v_exp_f32 v100, v100
    v_exp_f32 v101, v101
    v_cvt_pk_bf16_f32 v52, v96, v97
    v_exp_f32 v102, v102
    v_exp_f32 v103, v103
    v_cvt_pk_bf16_f32 v53, v98, v99
    v_cvt_pk_bf16_f32 v54, v100, v101
    v_cvt_pk_bf16_f32 v55, v102, v103
    v_mfma_f32_32x32x4_2b_bf16 v[72:103], v[20:21], v[8:9], 0
    v_exp_f32 v104, v104
    v_exp_f32 v105, v105
    v_exp_f32 v106, v106
    v_exp_f32 v107, v107
    v_exp_f32 v108, v108
    v_exp_f32 v109, v109
    v_cvt_pk_bf16_f32 v40, v104, v105
    v_exp_f32 v110, v110
    v_exp_f32 v111, v111
    v_cvt_pk_bf16_f32 v41, v106, v107
    v_mfma_f32_32x32x16_bf16 v[56:71], v[36:39], v[52:55], v[56:71]
    s_mov_b64 exec, s[94:95]
    ds_read_b128 v[32:35], v164 offset:4480
    ds_read_b128 v[36:39], v164 offset:4800
    s_mov_b64 exec, -1
    v_cvt_pk_bf16_f32 v42, v108, v109
    v_cvt_pk_bf16_f32 v43, v110, v111
    v_exp_f32 v112, v112
    v_exp_f32 v113, v113
    v_exp_f32 v114, v114
    v_exp_f32 v115, v115
    s_waitcnt lgkmcnt(2)
    v_mfma_f32_32x32x16_bf16 v[56:71], v[24:27], v[40:43], v[56:71]
    v_exp_f32 v116, v116
    v_exp_f32 v117, v117
    v_cvt_pk_bf16_f32 v44, v112, v113
    v_exp_f32 v118, v118
    v_exp_f32 v119, v119
    v_cvt_pk_bf16_f32 v45, v114, v115
    v_mfma_f32_32x32x16_bf16 v[72:87], v[12:15], v[4:7], v[72:87]
    v_cvt_pk_bf16_f32 v46, v116, v117
    v_cvt_pk_bf16_f32 v47, v118, v119
    v_exp_f32 v120, v120
    v_exp_f32 v121, v121
    v_exp_f32 v122, v122
    v_exp_f32 v123, v123
    v_mfma_f32_32x32x16_bf16 v[56:71], v[28:31], v[44:47], v[56:71]
    v_exp_f32 v124, v124
    v_exp_f32 v125, v125
    v_cvt_pk_bf16_f32 v48, v120, v121
    v_exp_f32 v126, v126
    v_exp_f32 v127, v127
    v_cvt_pk_bf16_f32 v49, v122, v123
    v_mfma_f32_32x32x16_bf16 v[88:103], v[16:19], v[4:7], v[88:103]
    ds_read_b128 v[12:15], v164 offset:11264
    ds_read_b128 v[16:19], v164 offset:11776
    s_mov_b64 exec, s[94:95]
    ds_read_b128 v[24:27], v164 offset:12800
    ds_read_b128 v[28:31], v164 offset:13120
    s_mov_b64 exec, -1
    v_cvt_pk_bf16_f32 v50, v124, v125
    v_cvt_pk_bf16_f32 v51, v126, v127
    v_exp_f32 v128, v128
    v_exp_f32 v129, v129
    v_exp_f32 v130, v130
    v_exp_f32 v131, v131
    s_waitcnt lgkmcnt(4)
    v_mfma_f32_32x32x16_bf16 v[56:71], v[32:35], v[48:51], v[56:71]
    v_exp_f32 v132, v132
    v_exp_f32 v133, v133
    v_cvt_pk_bf16_f32 v52, v128, v129
    v_exp_f32 v134, v134
    v_exp_f32 v135, v135
    v_cvt_pk_bf16_f32 v53, v130, v131
    v_cvt_pk_bf16_f32 v54, v132, v133
    v_cvt_pk_bf16_f32 v55, v134, v135
    v_add_u32 v164, 10240, v164
    s_sub_u32 s39, s39, 1
    s_cmp_lg_u32 s39, 0
    s_cbranch_scc1 K2_loop2
    v_mfma_f32_32x32x16_bf16 v[56:71], v[36:39], v[52:55], v[56:71]
    s_mov_b32 s46, 0x2b800000
    s_mov_b32 s47, 0x5d800000
    s_mov_b32 s48, 0x7d800000
    s_nop 8
    v_mul_f32 v40, s47, v68
    v_cmp_nle_f32 vcc, s46, v68
    v_add_f32 v41, abs(v56), abs(v57)
    v_add_f32 v40, abs(v58), v40
    v_add_f32 v41, abs(v59), v41
    v_add_f32 v40, abs(v60), v40
    v_add_f32 v41, abs(v61), v41
    v_add_f32 v40, abs(v62), v40
    v_add_f32 v41, abs(v63), v41
    v_add_f32 v40, abs(v64), v40
    v_add_f32 v41, abs(v65), v41
    v_add_f32 v40, abs(v66), v40
    v_add_f32 v41, abs(v67), v41
    v_add_f32 v40, v40, v41
    v_cmp_nge_f32 s[46:47], s48, v40
    s_waitcnt lgkmcnt(0)
    s_or_b64 vcc, vcc, s[46:47]
    s_cbranch_scc1 K2_slow
K2_fin:
    v_rcp_f32 v40, v68
    v_mov_b32 v4, s68
    v_lshlrev_b32 v5, 2, v0
    s_waitcnt vmcnt(0)
    v_mul_f32 v56, v56, v40
    v_mul_f32 v57, v57, v40
    v_mul_f32 v58, v58, v40
    v_mul_f32 v59, v59, v40
    v_mul_f32 v60, v60, v40
    v_mul_f32 v61, v61, v40
    v_mul_f32 v62, v62, v40
    v_mul_f32 v63, v63, v40
    v_mul_f32 v64, v64, v40
    v_mul_f32 v65, v65, v40
    v_mul_f32 v66, v66, v40
    v_mul_f32 v67, v67, v40
    v_cvt_pk_bf16_f32 v72, v56, v57
    v_cvt_pk_bf16_f32 v73, v58, v59
    v_cvt_pk_bf16_f32 v74, v60, v61
    v_cvt_pk_bf16_f32 v75, v62, v63
    v_cvt_pk_bf16_f32 v76, v64, v65
    v_cvt_pk_bf16_f32 v77, v66, v67
    buffer_store_dwordx4 v[72:75], v2, s[28:31], s91 offen sc1
    s_mov_b32 exec_hi, 0
    buffer_store_dwordx2 v[76:77], v2, s[28:31], s90 offen sc1
    s_mov_b64 exec, 1
    buffer_store_dword v4, v5, s[28:31], s92 offen sc1
    s_mov_b64 exec, -1
    s_and_b32 s40, s2, 7
    s_lshl_b32 s35, s40, 2
    s_bfe_u32 s40, s2, 0x20003
    s_add_u32 s35, s35, s40
    s_lshr_b32 s36, s2, 5
    s_mov_b32 s20, s8
    s_mov_b32 s21, s9
    s_mov_b32 s22, 2621440
    s_mov_b32 s23, 0x00020000
    s_mov_b32 s24, s18
    s_mov_b32 s25, s19
    s_mov_b32 s26, 2621440
    s_mov_b32 s27, 0x00020000
    s_lshl_b32 s40, s32, 6
    v_add_u32 v4, s40, v0
    v_mul_u32_u24 v5, 6554, v4
    v_lshrrev_b32 v5, 16, v5
    v_mul_u32_u24 v5, 1120, v5
    v_lshl_add_u32 v5, v4, 4, v5
    s_mul_i32 s60, s35, 81920
    s_mul_i32 s41, s36, 160
    s_add_u32 s60, s60, s41
    buffer_load_dwordx4 v[164:167], v5, s[20:23], s60 offen
    s_barrier
    s_waitcnt vmcnt(0)
K3_bar:
    s_lshl_b32 s40, s32, 10
    s_add_u32 s40, s40, 51200
    v_add_u32 v4, s40, v2
    v_add_u32 v6, 40960, v4
    v_lshlrev_b32 v140, 16, v164
    v_and_b32 v141, 0xffff0000, v164
    v_lshlrev_b32 v142, 16, v165
    v_and_b32 v143, 0xffff0000, v165
    v_lshlrev_b32 v144, 16, v166
    v_and_b32 v145, 0xffff0000, v166
    v_lshlrev_b32 v146, 16, v167
    v_and_b32 v147, 0xffff0000, v167
    s_waitcnt lgkmcnt(0)
    s_barrier
    ds_read_b128 v[108:111], v4 offset:0
    ds_read_b128 v[112:115], v4 offset:10240
    ds_read_b128 v[116:119], v4 offset:20480
    ds_read_b128 v[120:123], v4 offset:30720
    ds_read_b128 v[124:127], v6 offset:0
    ds_read_b128 v[128:131], v6 offset:10240
    ds_read_b128 v[132:135], v6 offset:20480
    ds_read_b128 v[136:139], v6 offset:30720
    s_waitcnt lgkmcnt(6)
    v_pk_add_f32 v[140:141], v[140:141], v[108:109]
    v_pk_add_f32 v[142:143], v[142:143], v[110:111]
    v_pk_add_f32 v[144:145], v[144:145], v[112:113]
    v_pk_add_f32 v[146:147], v[146:147], v[114:115]
    s_waitcnt lgkmcnt(4)
    v_pk_add_f32 v[140:141], v[140:141], v[116:117]
    v_pk_add_f32 v[142:143], v[142:143], v[118:119]
    v_pk_add_f32 v[144:145], v[144:145], v[120:121]
    v_pk_add_f32 v[146:147], v[146:147], v[122:123]
    s_waitcnt lgkmcnt(2)
    v_pk_add_f32 v[140:141], v[140:141], v[124:125]
    v_pk_add_f32 v[142:143], v[142:143], v[126:127]
    v_pk_add_f32 v[144:145], v[144:145], v[128:129]
    v_pk_add_f32 v[146:147], v[146:147], v[130:131]
    s_waitcnt lgkmcnt(0)
    v_pk_add_f32 v[140:141], v[140:141], v[132:133]
    v_pk_add_f32 v[142:143], v[142:143], v[134:135]
    v_pk_add_f32 v[144:145], v[144:145], v[136:137]
    v_pk_add_f32 v[146:147], v[146:147], v[138:139]
    v_cvt_pk_bf16_f32 v164, v140, v141
    v_cvt_pk_bf16_f32 v165, v142, v143
    v_cvt_pk_bf16_f32 v166, v144, v145
    v_cvt_pk_bf16_f32 v167, v146, v147
    buffer_store_dwordx4 v[164:167], v5, s[24:27], s60 offen
K_pe:
K_end:
    s_endpgm
K2_G:
    s_and_b32 s40, s2, 3
    s_lshl_b32 s35, s40, 2
    s_bfe_u32 s40, s2, 0x20003
    s_add_u32 s35, s35, s40
    s_bfe_u32 s40, s2, 0x10002
    s_lshl_b32 s37, s40, 1
    s_lshr_b32 s40, s2, 7
    s_add_u32 s37, s37, s40
    s_lshl_b32 s37, s37, 3
    s_bfe_u32 s40, s2, 0x20005
    s_add_u32 s37, s37, s40
    s_and_b32 s33, s32, 3
    s_lshl_b32 s38, s35, 2
    s_add_u32 s38, s38, s33
    v_lshlrev_b32 v2, 4, v0
    s_lshr_b32 s41, s38, 1
    s_lshl_b32 s40, s33, 10
    s_add_u32 s43, s40, 3145728
    s_mov_b32 m0, s40
    s_mul_i32 s42, s37, 5
    s_lshr_b32 s42, s42, 2
    v_bfe_u32 v4, v0, 1, 1
    v_and_b32 v5, 1, v0
    v_mad_u32_u24 v4, v4, 5, v5
    v_add_u32 v4, s42, v4
    v_lshrrev_b32 v4, 1, v4
    v_lshl_add_u32 v4, v4, 5, s41
    v_lshlrev_b32 v4, 7, v4
    v_add_u32 v4, 16777216, v4
    s_lshl_b32 s40, s33, 8
    s_add_u32 s40, s40, s2
    s_and_b32 s40, s40, 63
    s_lshl_b32 s40, s40, 7
    s_add_u32 s40, s40, 17170432
    v_writelane_b32 v4, s40, 0
    s_mul_i32 s54, s38, 40
    s_add_u32 s54, s54, s42
    s_lshl_b32 s54, s54, 10
    s_mov_b32 s53, 0
    s_mov_b32 s52, 1
    buffer_load_dword v5, v4, s[28:31], 0 offen sc1
    s_and_b32 s40, s2, 7
    s_lshl_b32 s35, s40, 2
    s_bfe_u32 s40, s2, 0x20003
    s_add_u32 s35, s35, s40
    s_lshr_b32 s36, s2, 5
    v_and_b32 v3, 15, v0
    v_lshlrev_b32 v3, 4, v3
    v_lshrrev_b32 v6, 5, v0
    v_lshl_add_u32 v3, v6, 8, v3
    v_bfe_u32 v6, v0, 4, 1
    v_lshl_add_u32 v1, v6, 9, v3
    v_lshl_add_u32 v3, v6, 30, v3
    s_mul_i32 s40, s36, 5
    s_lshr_b32 s40, s40, 2
    v_and_b32 v6, 1, v0
    v_add_u32 v11, s40, v6
    v_lshrrev_b32 v12, 1, v0
    v_min_u32 v9, 23, v12
    s_mul_i32 s40, s33, 24
    v_add_u32 v9, s40, v9
    v_mad_u32_u24 v9, v9, 10, v11
    v_lshlrev_b32 v9, 7, v9
    v_add_u32 v9, 17563648, v9
    v_and_b32 v12, 15, v12
    v_min_u32 v13, 9, v12
    s_mul_i32 s40, s33, 10
    v_add_u32 v13, s40, v13
    v_mad_u32_u24 v13, v13, 10, v11
    v_add_u32 v13, 6144, v13
    s_lshl_b32 s40, s35, 1
    v_add_u32 v6, s40, v6
    v_mul_u32_u24 v6, 205, v6
    v_lshrrev_b32 v6, 10, v6
    v_min_u32 v12, 11, v12
    s_mul_i32 s40, s33, 12
    s_add_u32 s40, s40, 20
    v_add_u32 v12, s40, v12
    v_cmp_gt_u32 vcc, 32, v0
    v_lshl_add_u32 v10, v12, 5, v6
    v_bfe_u32 v6, v0, 2, 2
    v_cndmask_b32 v10, v13, v10, vcc
    v_lshlrev_b32 v10, 7, v10
    v_add_u32 v10, 16777216, v10
    v_bfe_u32 v11, v0, 4, 1
    v_lshl_add_u32 v6, v6, 1, v11
    v_and_b32 v11, 3, v0
    v_lshl_add_u32 v6, v6, 2, v11
    v_and_b32 v11, 32, v0
    v_add_u32 v6, v6, v11
    s_lshl_b32 s40, s33, 10
    s_add_u32 s40, s40, 122880
    v_lshl_add_u32 v8, v6, 3, s40
K2_p1:
    s_waitcnt vmcnt(0)
    v_cmp_ne_u32 vcc, s68, v5
    s_add_u32 s53, s53, 1
    s_cmp_ge_u32 s53, 200000
    s_cselect_b64 vcc, 0, vcc
    s_andn2_b32 s40, s52, vcc_lo
    s_cbranch_scc0 K2_p1b
    s_mov_b32 s52, 0
    s_mov_b32 s39, 10
K2_f1:
    buffer_load_dwordx4 v2, s[28:31], s43 offen sc1 lds
    s_add_u32 s43, s43, 4096
    s_add_u32 m0, m0, 4096
    s_sub_u32 s39, s39, 1
    s_cmp_lg_u32 s39, 0
    s_cbranch_scc1 K2_f1
K2_p1b:
    s_cmp_eq_u64 vcc, 0
    s_cbranch_scc1 K2_p1x
    s_sleep 4
    buffer_load_dword v5, v4, s[28:31], 0 offen sc1
    s_branch K2_p1
K2_p1x:
    s_mov_b32 s52, m0
    s_lshl_b32 s41, s33, 12
    s_add_u32 m0, s41, 147456
    s_add_u32 s55, s54, 3072
    buffer_load_dwordx4 v2, s[28:31], s54 offen offset:0 sc1 lds
    buffer_load_dwordx4 v2, s[28:31], s54 offen offset:1024 sc1 lds
    buffer_load_dwordx4 v2, s[28:31], s55 offen offset:2048 sc1 lds
    buffer_load_dwordx4 v2, s[28:31], s55 offen offset:3072 sc1 lds
    s_mov_b32 m0, s52
    s_setprio 3
    ds_read_b64_tr_b16 v[144:145], v8 offset:0
    ds_read_b64_tr_b16 v[146:147], v8 offset:4096
    ds_read_b64_tr_b16 v[148:149], v8 offset:512
    ds_read_b64_tr_b16 v[150:151], v8 offset:4608
    ds_read_b64_tr_b16 v[152:153], v8 offset:8192
    ds_read_b64_tr_b16 v[154:155], v8 offset:12288
    ds_read_b64_tr_b16 v[156:157], v8 offset:8704
    ds_read_b64_tr_b16 v[158:159], v8 offset:12800
    s_lshl_b32 s40, s33, 10
    s_add_u32 s40, s40, 65536
    v_add_u32 v4, s40, v2
    s_lshl_b32 s42, s65, 11
    s_add_u32 s42, s42, 13631488
    s_add_u32 s40, s42, 1966080
    s_cmp_lt_u32 s65, 400
    s_cselect_b32 s40, s40, 22020096
    s_cmp_eq_u32 s58, 0
    s_cselect_b32 s59, 22020096, s59
    s_lshl_b32 s41, s65, 7
    s_add_u32 s41, s41, 17563648
    v_mov_b32 v6, s68
    v_mov_b32 v5, s59
    v_writelane_b32 v5, s41, 1
    s_waitcnt vmcnt(0) lgkmcnt(0)
    s_barrier
    ds_read_b128 v[104:107], v4 offset:0
    ds_read_b128 v[108:111], v4 offset:4096
    ds_read_b128 v[112:115], v4 offset:8192
    ds_read_b128 v[116:119], v4 offset:12288
    ds_read_b128 v[120:123], v4 offset:16384
    ds_read_b128 v[124:127], v4 offset:20480
    ds_read_b128 v[128:131], v4 offset:24576
    ds_read_b128 v[132:135], v4 offset:28672
    ds_read_b128 v[136:139], v4 offset:32768
    ds_read_b128 v[140:143], v4 offset:36864
    s_waitcnt lgkmcnt(0)
    s_mov_b32 s39, 26
K2_f2:
    buffer_load_dwordx4 v2, s[28:31], s43 offen sc1 lds
    s_add_u32 s43, s43, 4096
    s_add_u32 m0, m0, 4096
    s_sub_u32 s39, s39, 1
    s_cmp_lg_u32 s39, 0
    s_cbranch_scc1 K2_f2
    buffer_store_dwordx4 v[144:147], v1, s[28:31], s42 offen sc1
    buffer_store_dwordx4 v[148:151], v1, s[28:31], s42 offen offset:1024 sc1
    buffer_store_dwordx4 v[152:155], v1, s[28:31], s40 offen sc1
    buffer_store_dwordx4 v[156:159], v1, s[28:31], s40 offen offset:1024 sc1
    s_cmp_eq_u32 s58, 0
    s_waitcnt lgkmcnt(0)
    s_cbranch_scc1 K2_nh
    buffer_store_dwordx4 v[104:107], v2, s[28:31], s58 offen sc1
    buffer_store_dwordx4 v[108:111], v2, s[28:31], s58 offen offset:1024 sc1
    s_add_u32 s58, s58, 98304
    buffer_store_dwordx4 v[112:115], v2, s[28:31], s58 offen sc1
    buffer_store_dwordx4 v[116:119], v2, s[28:31], s58 offen offset:1024 sc1
    s_add_u32 s58, s58, 98304
    buffer_store_dwordx4 v[120:123], v2, s[28:31], s58 offen sc1
    buffer_store_dwordx4 v[124:127], v2, s[28:31], s58 offen offset:1024 sc1
    s_add_u32 s58, s58, 98304
    buffer_store_dwordx4 v[128:131], v2, s[28:31], s58 offen sc1
    buffer_store_dwordx4 v[132:135], v2, s[28:31], s58 offen offset:1024 sc1
    s_add_u32 s58, s58, 98304
    s_cmp_lt_u32 s58, 9699328
    s_cselect_b32 s58, s58, 22020096
    buffer_store_dwordx4 v[136:139], v2, s[28:31], s58 offen sc1
    buffer_store_dwordx4 v[140:143], v2, s[28:31], s58 offen offset:1024 sc1
    s_add_u32 s58, s58, 98304
K2_nh:
    s_mov_b64 exec, 3
    s_waitcnt vmcnt(0)
    buffer_store_dword v6, v5, s[28:31], 0 offen sc1
    s_mov_b64 exec, -1
    s_barrier
    s_mov_b32 s39, 4
K2_f5:
    buffer_load_dwordx4 v2, s[28:31], s43 offen sc1 lds
    s_add_u32 s43, s43, 4096
    s_add_u32 m0, m0, 4096
    s_sub_u32 s39, s39, 1
    s_cmp_lg_u32 s39, 0
    s_cbranch_scc1 K2_f5
    s_mul_i32 s46, s35, 192
    s_mul_i32 s40, s33, 24
    s_add_u32 s46, s46, s40
    s_lshl_b32 s46, s46, 10
    s_add_u32 s46, s46, 3407872
    s_add_u32 s47, s46, 98304
    s_mul_i32 s48, s40, 20480
    s_mul_i32 s40, s36, 2560
    s_add_u32 s48, s48, s40
    s_add_u32 s48, s48, 13631488
    s_mov_b32 s53, 0
    s_mov_b64 s[60:61], -1
    s_mov_b64 s[62:63], -1
K2_p3:
    s_mov_b64 exec, s[60:61]
    buffer_load_dword v4, v9, s[28:31], 0 offen sc1
    s_mov_b64 exec, s[62:63]
    buffer_load_dword v5, v10, s[28:31], 0 offen sc1
    s_mov_b64 exec, -1
    s_add_u32 s53, s53, 1
    s_waitcnt vmcnt(0)
    v_cmp_ne_u32 s[60:61], s68, v4
    v_cmp_ne_u32 s[62:63], s68, v5
    s_nop 0
    s_or_b64 vcc, s[60:61], s[62:63]
    s_cbranch_scc0 K2_p3x
    s_or_b32 s60, s60, 1
    s_or_b32 s62, s62, 1
    s_sleep 16
    s_cmp_lt_u32 s53, 200000
    s_cbranch_scc1 K2_p3
K2_p3x:
    buffer_load_dwordx4 v[104:107], v2, s[28:31], s46 offen offset:0 sc1
    buffer_load_dwordx4 v[108:111], v2, s[28:31], s47 offen offset:0 sc1
    buffer_load_dwordx4 v[112:115], v1, s[28:31], s48 offen sc1
    buffer_load_dwordx4 v[116:119], v1, s[28:31], s48 offen offset:1024 sc1
    buffer_load_dwordx4 v[120:123], v3, s[28:31], s48 offen offset:2048 sc1
    s_add_u32 s48, s48, 20480
    buffer_load_dwordx4 v[124:127], v2, s[28:31], s46 offen offset:1024 sc1
    buffer_load_dwordx4 v[128:131], v2, s[28:31], s47 offen offset:1024 sc1
    buffer_load_dwordx4 v[132:135], v1, s[28:31], s48 offen sc1
    buffer_load_dwordx4 v[136:139], v1, s[28:31], s48 offen offset:1024 sc1
    buffer_load_dwordx4 v[140:143], v3, s[28:31], s48 offen offset:2048 sc1
    s_add_u32 s48, s48, 20480
    buffer_load_dwordx4 v[144:147], v2, s[28:31], s46 offen offset:2048 sc1
    buffer_load_dwordx4 v[148:151], v2, s[28:31], s47 offen offset:2048 sc1
    buffer_load_dwordx4 v[152:155], v1, s[28:31], s48 offen sc1
    buffer_load_dwordx4 v[156:159], v1, s[28:31], s48 offen offset:1024 sc1
    buffer_load_dwordx4 v[160:163], v3, s[28:31], s48 offen offset:2048 sc1
    s_add_u32 s48, s48, 20480
    s_lshl_b32 s40, s35, 3
    s_add_u32 s40, s40, s33
    s_lshl_b32 s40, s40, 10
    s_add_u32 s40, s40, 17301504
    v_and_b32 v7, 35, v0
    v_lshl_add_u32 v7, v7, 7, s40
    s_setprio 0
    s_mov_b32 s39, 5
    s_mov_b32 s52, 0
    s_waitcnt vmcnt(10)
    v_mfma_f32_32x32x16_bf16 v[8:23], v[112:115], v[104:107], 0
    v_mfma_f32_32x32x16_bf16 v[56:71], v[112:115], v[108:111], 0
    v_mfma_f32_32x32x16_bf16 v[24:39], v[116:119], v[104:107], 0
    v_mfma_f32_32x32x16_bf16 v[72:87], v[116:119], v[108:111], 0
    v_mfma_f32_32x32x16_bf16 v[40:55], v[120:123], v[104:107], 0
    v_mfma_f32_32x32x16_bf16 v[88:103], v[120:123], v[108:111], 0
    s_branch K2_Gm
K2_Gl:
    s_waitcnt vmcnt(10)
    v_mfma_f32_32x32x16_bf16 v[8:23], v[112:115], v[104:107], v[8:23]
    v_mfma_f32_32x32x16_bf16 v[56:71], v[112:115], v[108:111], v[56:71]
    v_mfma_f32_32x32x16_bf16 v[24:39], v[116:119], v[104:107], v[24:39]
    v_mfma_f32_32x32x16_bf16 v[72:87], v[116:119], v[108:111], v[72:87]
    v_mfma_f32_32x32x16_bf16 v[40:55], v[120:123], v[104:107], v[40:55]
    v_mfma_f32_32x32x16_bf16 v[88:103], v[120:123], v[108:111], v[88:103]
K2_Gm:
    s_add_u32 s46, s46, 3072
    s_add_u32 s47, s47, 3072
    buffer_load_dwordx4 v[104:107], v2, s[28:31], s46 offen offset:0 sc1
    buffer_load_dwordx4 v[108:111], v2, s[28:31], s47 offen offset:0 sc1
    buffer_load_dwordx4 v[112:115], v1, s[28:31], s48 offen sc1
    buffer_load_dwordx4 v[116:119], v1, s[28:31], s48 offen offset:1024 sc1
    buffer_load_dwordx4 v[120:123], v3, s[28:31], s48 offen offset:2048 sc1
    s_add_u32 s48, s48, 20480
    s_waitcnt vmcnt(10)
    v_mfma_f32_32x32x16_bf16 v[8:23], v[132:135], v[124:127], v[8:23]
    v_mfma_f32_32x32x16_bf16 v[56:71], v[132:135], v[128:131], v[56:71]
    v_mfma_f32_32x32x16_bf16 v[24:39], v[136:139], v[124:127], v[24:39]
    v_mfma_f32_32x32x16_bf16 v[72:87], v[136:139], v[128:131], v[72:87]
    v_mfma_f32_32x32x16_bf16 v[40:55], v[140:143], v[124:127], v[40:55]
    v_mfma_f32_32x32x16_bf16 v[88:103], v[140:143], v[128:131], v[88:103]
    buffer_load_dwordx4 v[124:127], v2, s[28:31], s46 offen offset:1024 sc1
    buffer_load_dwordx4 v[128:131], v2, s[28:31], s47 offen offset:1024 sc1
    buffer_load_dwordx4 v[132:135], v1, s[28:31], s48 offen sc1
    buffer_load_dwordx4 v[136:139], v1, s[28:31], s48 offen offset:1024 sc1
    buffer_load_dwordx4 v[140:143], v3, s[28:31], s48 offen offset:2048 sc1
    s_add_u32 s48, s48, 20480
    s_waitcnt vmcnt(10)
    v_mfma_f32_32x32x16_bf16 v[8:23], v[152:155], v[144:147], v[8:23]
    v_mfma_f32_32x32x16_bf16 v[56:71], v[152:155], v[148:151], v[56:71]
    v_mfma_f32_32x32x16_bf16 v[24:39], v[156:159], v[144:147], v[24:39]
    v_mfma_f32_32x32x16_bf16 v[72:87], v[156:159], v[148:151], v[72:87]
    v_mfma_f32_32x32x16_bf16 v[40:55], v[160:163], v[144:147], v[40:55]
    v_mfma_f32_32x32x16_bf16 v[88:103], v[160:163], v[148:151], v[88:103]
    buffer_load_dwordx4 v[144:147], v2, s[28:31], s46 offen offset:2048 sc1
    buffer_load_dwordx4 v[148:151], v2, s[28:31], s47 offen offset:2048 sc1
    buffer_load_dwordx4 v[152:155], v1, s[28:31], s48 offen sc1
    buffer_load_dwordx4 v[156:159], v1, s[28:31], s48 offen offset:1024 sc1
    buffer_load_dwordx4 v[160:163], v3, s[28:31], s48 offen offset:2048 sc1
    s_add_u32 s48, s48, 20480
    s_sub_u32 s39, s39, 1
    s_cmp_lg_u32 s39, 0
    s_cbranch_scc1 K2_Gl
    s_cmp_lg_u32 s52, 0
    s_cbranch_scc1 K2_Gt
    s_setprio 3
    s_mul_i32 s42, s33, 12800
    s_add_u32 s42, s42, 51200
    s_mul_i32 s54, s33, 204800
    s_mul_i32 s40, s36, 2560
    s_add_u32 s54, s54, s40
    s_add_u32 s54, s54, 15597568
    s_mov_b32 m0, s42
    v_add_u32 v4, s42, v1
    v_add_u32 v6, s42, v3
    s_mul_i32 s55, s35, 80
    s_mul_i32 s40, s33, 10
    s_add_u32 s55, s55, s40
    s_lshl_b32 s55, s55, 10
    s_add_u32 s55, s55, 9699328
    s_add_u32 s56, s55, 40960
    s_add_u32 s49, s55, 4096
    s_add_u32 s50, s56, 4096
    s_mov_b32 s39, 10
    s_barrier
K2_f4:
    buffer_load_dwordx4 v2, s[28:31], s54 offen sc1 lds
    buffer_load_dwordx4 v2, s[28:31], s54 offen offset:1024 sc1 lds
    s_mov_b32 exec_hi, 0
    buffer_load_dwordx4 v2, s[28:31], s54 offen offset:2048 sc1 lds
    s_mov_b32 exec_hi, -1
    s_add_u32 s54, s54, 20480
    s_cmp_eq_u32 s39, 6
    s_movk_i32 s40, 2560
    s_cselect_b32 s40, 4294905856, s40
    s_add_u32 m0, m0, s40
    s_sub_u32 s39, s39, 1
    s_cmp_lg_u32 s39, 0
    s_cbranch_scc1 K2_f4
    s_mov_b32 s20, s8
    s_mov_b32 s21, s9
    s_mov_b32 s22, 2621440
    s_mov_b32 s23, 0x00020000
    s_mov_b32 s24, s18
    s_mov_b32 s25, s19
    s_mov_b32 s26, 2621440
    s_mov_b32 s27, 0x00020000
    s_lshl_b32 s40, s32, 6
    v_add_u32 v164, s40, v0
    v_mul_u32_u24 v5, 6554, v164
    v_lshrrev_b32 v5, 16, v5
    v_mul_u32_u24 v5, 1120, v5
    v_lshl_add_u32 v5, v164, 4, v5
    s_mul_i32 s60, s35, 81920
    s_mul_i32 s41, s36, 160
    s_add_u32 s60, s60, s41
    buffer_load_dwordx4 v[164:167], v5, s[20:23], s60 offen
    s_mov_b32 s51, 200000
    s_mov_b32 s39, 2
    s_mov_b32 s52, 1
    s_waitcnt vmcnt(0)
    s_setprio 1
    s_branch K2_Gl
K2_Gt:
    buffer_load_dword v3, v7, s[28:31], 0 offen sc1
    s_waitcnt vmcnt(11)
    v_mfma_f32_32x32x16_bf16 v[8:23], v[112:115], v[104:107], v[8:23]
    v_mfma_f32_32x32x16_bf16 v[56:71], v[112:115], v[108:111], v[56:71]
    v_mfma_f32_32x32x16_bf16 v[24:39], v[116:119], v[104:107], v[24:39]
    v_mfma_f32_32x32x16_bf16 v[72:87], v[116:119], v[108:111], v[72:87]
    v_mfma_f32_32x32x16_bf16 v[40:55], v[120:123], v[104:107], v[40:55]
    v_mfma_f32_32x32x16_bf16 v[88:103], v[120:123], v[108:111], v[88:103]
    s_waitcnt vmcnt(6)
    v_mfma_f32_32x32x16_bf16 v[8:23], v[132:135], v[124:127], v[8:23]
    v_mfma_f32_32x32x16_bf16 v[56:71], v[132:135], v[128:131], v[56:71]
    v_mfma_f32_32x32x16_bf16 v[24:39], v[136:139], v[124:127], v[24:39]
    v_mfma_f32_32x32x16_bf16 v[72:87], v[136:139], v[128:131], v[72:87]
    v_mfma_f32_32x32x16_bf16 v[40:55], v[140:143], v[124:127], v[40:55]
    v_mfma_f32_32x32x16_bf16 v[88:103], v[140:143], v[128:131], v[88:103]
    s_waitcnt vmcnt(1)
    v_mfma_f32_32x32x16_bf16 v[8:23], v[152:155], v[144:147], v[8:23]
    v_mfma_f32_32x32x16_bf16 v[56:71], v[152:155], v[148:151], v[56:71]
    v_mfma_f32_32x32x16_bf16 v[24:39], v[156:159], v[144:147], v[24:39]
    v_mfma_f32_32x32x16_bf16 v[72:87], v[156:159], v[148:151], v[72:87]
    v_mfma_f32_32x32x16_bf16 v[40:55], v[160:163], v[144:147], v[40:55]
    v_mfma_f32_32x32x16_bf16 v[88:103], v[160:163], v[148:151], v[88:103]
    s_mov_b32 s52, 0
    v_mov_b32 v1, 0x40000000
K3_ph:
    ds_read_b128 v[144:147], v4 offset:0
    ds_read_b128 v[148:151], v4 offset:2560
    ds_read_b128 v[152:155], v4 offset:5120
    ds_read_b128 v[156:159], v4 offset:7680
    ds_read_b128 v[160:163], v4 offset:10240
    s_waitcnt vmcnt(0)
    v_cmp_ne_u32 vcc, s68, v3
    s_cbranch_vccz K2_p4x
    s_mov_b32 s53, 0
K2_p4:
    buffer_load_dword v3, v7, s[28:31], 0 offen sc1
    s_add_u32 s53, s53, 1
    s_waitcnt vmcnt(0)
    v_cmp_ne_u32 vcc, s68, v3
    s_cbranch_vccz K2_p4x
    s_sleep 4
    s_cmp_lt_u32 s53, 200000
    s_cbranch_scc1 K2_p4
K2_p4x:
    buffer_load_dwordx4 v[104:107], v2, s[28:31], s55 offen offset:0 sc1
    buffer_load_dwordx4 v[108:111], v2, s[28:31], s56 offen offset:0 sc1
    buffer_load_dwordx4 v[112:115], v2, s[28:31], s55 offen offset:1024 sc1
    buffer_load_dwordx4 v[116:119], v2, s[28:31], s56 offen offset:1024 sc1
    buffer_load_dwordx4 v[120:123], v2, s[28:31], s55 offen offset:2048 sc1
    buffer_load_dwordx4 v[124:127], v2, s[28:31], s56 offen offset:2048 sc1
    buffer_load_dwordx4 v[128:131], v2, s[28:31], s55 offen offset:3072 sc1
    buffer_load_dwordx4 v[132:135], v2, s[28:31], s56 offen offset:3072 sc1
    buffer_load_dwordx4 v[136:139], v2, s[28:31], s49 offen offset:0 sc1
    buffer_load_dwordx4 v[140:143], v2, s[28:31], s50 offen offset:0 sc1
    v_add_u32 v7, 512, v7
    s_cmp_eq_u32 s52, 0
    s_cbranch_scc1 K3_nb
    s_barrier
K3_nb:
    s_waitcnt vmcnt(8) lgkmcnt(4)
K3_c0:
    v_max3_u32 v3, v104, v106, v108
    v_max_u32 v3, v3, v110
    v_cmp_eq_u32 vcc, -1, v3
    s_cbranch_vccnz K3_r0
K3_m0:
    v_mfma_f32_32x32x16_bf16 v[8:23], v[144:147], v[104:107], v[8:23]
    v_mfma_f32_32x32x16_bf16 v[56:71], v[144:147], v[108:111], v[56:71]
    ds_read_b128 v[144:147], v4 offset:1024
    s_waitcnt vmcnt(6) lgkmcnt(4)
K3_c1:
    v_max3_u32 v3, v112, v114, v116
    v_max_u32 v3, v3, v118
    v_cmp_eq_u32 vcc, -1, v3
    s_cbranch_vccnz K3_r1
K3_m1:
    v_mfma_f32_32x32x16_bf16 v[8:23], v[148:151], v[112:115], v[8:23]
    v_mfma_f32_32x32x16_bf16 v[56:71], v[148:151], v[116:119], v[56:71]
    ds_read_b128 v[148:151], v4 offset:3584
    s_waitcnt vmcnt(4) lgkmcnt(4)
K3_c2:
    v_max3_u32 v3, v120, v122, v124
    v_max_u32 v3, v3, v126
    v_cmp_eq_u32 vcc, -1, v3
    s_cbranch_vccnz K3_r2
K3_m2:
    v_mfma_f32_32x32x16_bf16 v[8:23], v[152:155], v[120:123], v[8:23]
    v_mfma_f32_32x32x16_bf16 v[56:71], v[152:155], v[124:127], v[56:71]
    ds_read_b128 v[152:155], v4 offset:6144
    s_waitcnt vmcnt(2) lgkmcnt(4)
K3_c3:
    v_max3_u32 v3, v128, v130, v132
    v_max_u32 v3, v3, v134
    v_cmp_eq_u32 vcc, -1, v3
    s_cbranch_vccnz K3_r3
K3_m3:
    v_mfma_f32_32x32x16_bf16 v[8:23], v[156:159], v[128:131], v[8:23]
    v_mfma_f32_32x32x16_bf16 v[56:71], v[156:159], v[132:135], v[56:71]
    ds_read_b128 v[156:159], v4 offset:8704
    s_waitcnt vmcnt(0) lgkmcnt(4)
K3_c4:
    v_max3_u32 v3, v136, v138, v140
    v_max_u32 v3, v3, v142
    v_cmp_eq_u32 vcc, -1, v3
    s_cbranch_vccnz K3_r4
K3_m4:
    v_mfma_f32_32x32x16_bf16 v[8:23], v[160:163], v[136:139], v[8:23]
    v_mfma_f32_32x32x16_bf16 v[56:71], v[160:163], v[140:143], v[56:71]
    ds_read_b128 v[160:163], v4 offset:11264
    s_waitcnt lgkmcnt(4)
    v_mfma_f32_32x32x16_bf16 v[24:39], v[144:147], v[104:107], v[24:39]
    v_mfma_f32_32x32x16_bf16 v[72:87], v[144:147], v[108:111], v[72:87]
    s_nop 7
    ds_read_b128 v[144:147], v6 offset:2048
    s_waitcnt lgkmcnt(4)
    v_mfma_f32_32x32x16_bf16 v[24:39], v[148:151], v[112:115], v[24:39]
    ds_write_b128 v1, v[8:11] offset:0
    v_mfma_f32_32x32x16_bf16 v[72:87], v[148:151], v[116:119], v[72:87]
    ds_write_b128 v1, v[12:15] offset:16
    ds_read_b128 v[148:151], v6 offset:4608
    s_waitcnt lgkmcnt(6)
    v_mfma_f32_32x32x16_bf16 v[24:39], v[152:155], v[120:123], v[24:39]
    ds_write_b128 v1, v[16:19] offset:32
    v_mfma_f32_32x32x16_bf16 v[72:87], v[152:155], v[124:127], v[72:87]
    ds_write_b128 v1, v[20:23] offset:48
    ds_read_b128 v[152:155], v6 offset:7168
    s_waitcnt lgkmcnt(8)
    v_mfma_f32_32x32x16_bf16 v[24:39], v[156:159], v[128:131], v[24:39]
    ds_write_b128 v1, v[56:59] offset:5120
    v_mfma_f32_32x32x16_bf16 v[72:87], v[156:159], v[132:135], v[72:87]
    ds_write_b128 v1, v[60:63] offset:5136
    ds_read_b128 v[156:159], v6 offset:9728
    s_waitcnt lgkmcnt(10)
    v_mfma_f32_32x32x16_bf16 v[24:39], v[160:163], v[136:139], v[24:39]
    ds_write_b128 v1, v[64:67] offset:5152
    v_mfma_f32_32x32x16_bf16 v[72:87], v[160:163], v[140:143], v[72:87]
    ds_write_b128 v1, v[68:71] offset:5168
    ds_read_b128 v[160:163], v6 offset:12288
    s_waitcnt lgkmcnt(12)
    buffer_load_dword v3, v7, s[28:31], 0 offen sc1
    v_mfma_f32_32x32x16_bf16 v[40:55], v[144:147], v[104:107], v[40:55]
    v_mfma_f32_32x32x16_bf16 v[88:103], v[144:147], v[108:111], v[88:103]
    s_nop 7
    s_waitcnt lgkmcnt(9)
    v_mfma_f32_32x32x16_bf16 v[40:55], v[148:151], v[112:115], v[40:55]
    ds_write_b128 v1, v[24:27] offset:64
    v_mfma_f32_32x32x16_bf16 v[88:103], v[148:151], v[116:119], v[88:103]
    ds_write_b128 v1, v[28:31] offset:80
    s_waitcnt lgkmcnt(8)
    v_mfma_f32_32x32x16_bf16 v[40:55], v[152:155], v[120:123], v[40:55]
    ds_write_b128 v1, v[32:35] offset:96
    v_mfma_f32_32x32x16_bf16 v[88:103], v[152:155], v[124:127], v[88:103]
    ds_write_b128 v1, v[36:39] offset:112
    s_waitcnt lgkmcnt(7)
    v_mfma_f32_32x32x16_bf16 v[40:55], v[156:159], v[128:131], v[40:55]
    ds_write_b128 v1, v[72:75] offset:5184
    v_mfma_f32_32x32x16_bf16 v[88:103], v[156:159], v[132:135], v[88:103]
    ds_write_b128 v1, v[76:79] offset:5200
    s_waitcnt lgkmcnt(6)
    v_mfma_f32_32x32x16_bf16 v[40:55], v[160:163], v[136:139], v[40:55]
    ds_write_b128 v1, v[80:83] offset:5216
    v_mfma_f32_32x32x16_bf16 v[88:103], v[160:163], v[140:143], v[88:103]
    ds_write_b128 v1, v[84:87] offset:5232
    s_cmp_lg_u32 s52, 0
    s_cbranch_scc1 K3_pd
    s_mov_b32 s52, 1
    s_add_u32 s55, s55, 5120
    s_add_u32 s56, s56, 5120
    s_add_u32 s49, s49, 5120
    s_add_u32 s50, s50, 5120
    v_subrev_u32 v4, 51200, v4
    v_subrev_u32 v6, 51200, v6
    v_and_b32 v1, 31, v0
    v_mul_u32_u24 v1, 160, v1
    v_lshrrev_b32 v104, 5, v0
    v_mul_u32_u24 v104, 10240, v104
    s_mul_i32 s40, s33, 20480
    s_add_u32 s40, s40, 51200
    v_add3_u32 v1, v1, v104, s40
    s_setprio 3
    s_branch K3_ph
K3_pd:
    s_nop 9
    ds_write_b128 v1, v[40:43] offset:128
    ds_write_b128 v1, v[44:47] offset:144
    ds_write_b128 v1, v[88:91] offset:5248
    ds_write_b128 v1, v[92:95] offset:5264
    s_cmp_lt_u32 s32, 10
    s_cbranch_scc1 K3_bar
    s_waitcnt lgkmcnt(0)
    s_barrier
    s_endpgm
K3_r0:
    s_cmp_eq_u32 s51, 0
    s_cbranch_scc1 K3_m0
    s_sub_u32 s51, s51, 1
    buffer_load_dwordx4 v[104:107], v2, s[28:31], s55 offen offset:0 sc1
    buffer_load_dwordx4 v[108:111], v2, s[28:31], s56 offen offset:0 sc1
    s_waitcnt vmcnt(0)
    s_branch K3_c0
K3_r1:
    s_cmp_eq_u32 s51, 0
    s_cbranch_scc1 K3_m1
    s_sub_u32 s51, s51, 1
    buffer_load_dwordx4 v[112:115], v2, s[28:31], s55 offen offset:1024 sc1
    buffer_load_dwordx4 v[116:119], v2, s[28:31], s56 offen offset:1024 sc1
    s_waitcnt vmcnt(0)
    s_branch K3_c1
K3_r2:
    s_cmp_eq_u32 s51, 0
    s_cbranch_scc1 K3_m2
    s_sub_u32 s51, s51, 1
    buffer_load_dwordx4 v[120:123], v2, s[28:31], s55 offen offset:2048 sc1
    buffer_load_dwordx4 v[124:127], v2, s[28:31], s56 offen offset:2048 sc1
    s_waitcnt vmcnt(0)
    s_branch K3_c2
K3_r3:
    s_cmp_eq_u32 s51, 0
    s_cbranch_scc1 K3_m3
    s_sub_u32 s51, s51, 1
    buffer_load_dwordx4 v[128:131], v2, s[28:31], s55 offen offset:3072 sc1
    buffer_load_dwordx4 v[132:135], v2, s[28:31], s56 offen offset:3072 sc1
    s_waitcnt vmcnt(0)
    s_branch K3_c3
K3_r4:
    s_cmp_eq_u32 s51, 0
    s_cbranch_scc1 K3_m4
    s_sub_u32 s51, s51, 1
    buffer_load_dwordx4 v[136:139], v2, s[28:31], s49 offen offset:0 sc1
    buffer_load_dwordx4 v[140:143], v2, s[28:31], s50 offen offset:0 sc1
    s_waitcnt vmcnt(0)
    s_branch K3_c4
K_last:
K2_slow:
    v_subrev_u32 v164, 163840, v164
    v_mov_b32 v3, 0xff800000
    s_mov_b32 s48, 0
    v_mov_b32 v56, 0
    v_mov_b32 v57, 0
    v_mov_b32 v58, 0
    v_mov_b32 v59, 0
    v_mov_b32 v60, 0
    v_mov_b32 v61, 0
    v_mov_b32 v62, 0
    v_mov_b32 v63, 0
    v_mov_b32 v64, 0
    v_mov_b32 v65, 0
    v_mov_b32 v66, 0
    v_mov_b32 v67, 0
    v_mov_b32 v68, 0
    v_mov_b32 v69, 0
    v_mov_b32 v70, 0
    v_mov_b32 v71, 0
K2_sp:
    s_mov_b32 s39, 0
K2_sl:
    s_lshr_b32 s40, s39, 1
    s_mul_i32 s40, s40, 10240
    s_add_u32 s40, s40, 3145728
    s_and_b32 s41, s39, 1
    s_lshl_b32 s49, s41, 10
    s_add_u32 s49, s49, s40
    s_lshl_b32 s50, s41, 3
    s_add_u32 s50, s50, s40
    s_mul_i32 s51, s41, 1280
    s_add_u32 s51, s51, s40
    buffer_load_dwordx4 v[12:15], v164, s[28:31], s49 offen sc1
    buffer_load_dwordx4 v[16:19], v164, s[28:31], s49 offen offset:512 sc1
    buffer_load_dwordx2 v[20:21], v164, s[28:31], s50 offen offset:2048 sc1
    s_mov_b64 exec, s[94:95]
    buffer_load_dwordx4 v[24:27], v164, s[28:31], s51 offen offset:2560 sc1
    buffer_load_dwordx4 v[28:31], v164, s[28:31], s51 offen offset:2880 sc1
    buffer_load_dwordx4 v[32:35], v164, s[28:31], s51 offen offset:3200 sc1
    buffer_load_dwordx4 v[36:39], v164, s[28:31], s51 offen offset:3520 sc1
    s_mov_b64 exec, -1
    s_waitcnt vmcnt(0)
    v_mfma_f32_32x32x4_2b_bf16 v[72:103], v[20:21], v[8:9], 0
    s_nop 15
    s_nop 3
    v_mfma_f32_32x32x16_bf16 v[72:87], v[12:15], v[4:7], v[72:87]
    v_mfma_f32_32x32x16_bf16 v[88:103], v[16:19], v[4:7], v[88:103]
    s_cmp_lg_u32 s48, 0
    s_nop 12
    s_cbranch_scc1 K2_sp2
    v_max3_f32 v3, v72, v73, v3
    v_max3_f32 v3, v74, v75, v3
    v_max3_f32 v3, v76, v77, v3
    v_max3_f32 v3, v78, v79, v3
    v_max3_f32 v3, v80, v81, v3
    v_max3_f32 v3, v82, v83, v3
    v_max3_f32 v3, v84, v85, v3
    v_max3_f32 v3, v86, v87, v3
    v_max3_f32 v3, v88, v89, v3
    v_max3_f32 v3, v90, v91, v3
    v_max3_f32 v3, v92, v93, v3
    v_max3_f32 v3, v94, v95, v3
    v_max3_f32 v3, v96, v97, v3
    v_max3_f32 v3, v98, v99, v3
    v_max3_f32 v3, v100, v101, v3
    v_max3_f32 v3, v102, v103, v3
    s_branch K2_snext
K2_sp2:
    v_sub_f32 v72, v72, v3
    v_sub_f32 v73, v73, v3
    v_sub_f32 v74, v74, v3
    v_sub_f32 v75, v75, v3
    v_sub_f32 v76, v76, v3
    v_sub_f32 v77, v77, v3
    v_sub_f32 v78, v78, v3
    v_sub_f32 v79, v79, v3
    v_sub_f32 v80, v80, v3
    v_sub_f32 v81, v81, v3
    v_sub_f32 v82, v82, v3
    v_sub_f32 v83, v83, v3
    v_sub_f32 v84, v84, v3
    v_sub_f32 v85, v85, v3
    v_sub_f32 v86, v86, v3
    v_sub_f32 v87, v87, v3
    v_sub_f32 v88, v88, v3
    v_sub_f32 v89, v89, v3
    v_sub_f32 v90, v90, v3
    v_sub_f32 v91, v91, v3
    v_sub_f32 v92, v92, v3
    v_sub_f32 v93, v93, v3
    v_sub_f32 v94, v94, v3
    v_sub_f32 v95, v95, v3
    v_sub_f32 v96, v96, v3
    v_sub_f32 v97, v97, v3
    v_sub_f32 v98, v98, v3
    v_sub_f32 v99, v99, v3
    v_sub_f32 v100, v100, v3
    v_sub_f32 v101, v101, v3
    v_sub_f32 v102, v102, v3
    v_sub_f32 v103, v103, v3
    v_exp_f32 v72, v72
    v_exp_f32 v73, v73
    v_exp_f32 v74, v74
    v_exp_f32 v75, v75
    v_exp_f32 v76, v76
    v_exp_f32 v77, v77
    v_exp_f32 v78, v78
    v_exp_f32 v79, v79
    v_exp_f32 v80, v80
    v_exp_f32 v81, v81
    v_exp_f32 v82, v82
    v_exp_f32 v83, v83
    v_exp_f32 v84, v84
    v_exp_f32 v85, v85
    v_exp_f32 v86, v86
    v_exp_f32 v87, v87
    v_exp_f32 v88, v88
    v_exp_f32 v89, v89
    v_exp_f32 v90, v90
    v_exp_f32 v91, v91
    v_exp_f32 v92, v92
    v_exp_f32 v93, v93
    v_exp_f32 v94, v94
    v_exp_f32 v95, v95
    v_exp_f32 v96, v96
    v_exp_f32 v97, v97
    v_exp_f32 v98, v98
    v_exp_f32 v99, v99
    v_exp_f32 v100, v100
    v_exp_f32 v101, v101
    v_exp_f32 v102, v102
    v_exp_f32 v103, v103
    s_nop 0
    v_cvt_pk_bf16_f32 v40, v72, v73
    v_cvt_pk_bf16_f32 v41, v74, v75
    v_cvt_pk_bf16_f32 v42, v76, v77
    v_cvt_pk_bf16_f32 v43, v78, v79
    v_cvt_pk_bf16_f32 v44, v80, v81
    v_cvt_pk_bf16_f32 v45, v82, v83
    v_cvt_pk_bf16_f32 v46, v84, v85
    v_cvt_pk_bf16_f32 v47, v86, v87
    v_cvt_pk_bf16_f32 v48, v88, v89
    v_cvt_pk_bf16_f32 v49, v90, v91
    v_cvt_pk_bf16_f32 v50, v92, v93
    v_cvt_pk_bf16_f32 v51, v94, v95
    v_cvt_pk_bf16_f32 v52, v96, v97
    v_cvt_pk_bf16_f32 v53, v98, v99
    v_cvt_pk_bf16_f32 v54, v100, v101
    v_cvt_pk_bf16_f32 v55, v102, v103
    s_nop 1
    v_mfma_f32_32x32x16_bf16 v[56:71], v[24:27], v[40:43], v[56:71]
    v_mfma_f32_32x32x16_bf16 v[56:71], v[28:31], v[44:47], v[56:71]
    v_mfma_f32_32x32x16_bf16 v[56:71], v[32:35], v[48:51], v[56:71]
    v_mfma_f32_32x32x16_bf16 v[56:71], v[36:39], v[52:55], v[56:71]
    s_nop 15
K2_snext:
    s_add_u32 s39, s39, 1
    s_cmp_lt_u32 s39, 32
    s_cbranch_scc1 K2_sl
    s_cmp_lg_u32 s48, 0
    s_cbranch_scc1 K2_fin
    v_mov_b32 v40, v3
    s_nop 1
    v_permlane32_swap_b32 v40, v3
    s_mov_b32 s48, 1
    v_max_f32 v3, v3, v40
    s_branch K2_sp
.section .rodata,"a"
.p2align 6
.amdhsa_kernel parallel_sum__grouped_kv_mqa__dense_activation_silu__prompt_kernel
  .amdhsa_next_free_vgpr 168
  .amdhsa_next_free_sgpr 102
  .amdhsa_accum_offset 168
  .amdhsa_group_segment_fixed_size 0
  .amdhsa_kernarg_size 88
  .amdhsa_user_sgpr_count 2
  .amdhsa_user_sgpr_kernarg_segment_ptr 1
  .amdhsa_system_sgpr_workgroup_id_x 1
.end_amdhsa_kernel
```
